```python
import torch

def _softmax(x, axis=-1):
    return torch.softmax(x, dim=axis)
def _gelu(x):
    return torch.nn.functional.gelu(x, approximate="tanh")
def _silu(x):
    return torch.nn.functional.silu(x)
def _sigmoid(x):
    return torch.sigmoid(x)
def _layernorm(x, axis=-1, eps=1e-5):
    m = x.mean(dim=axis, keepdim=True)
    v = x.var(dim=axis, keepdim=True, unbiased=False)
    return (x - m) / torch.sqrt(v + eps)
def _scatter_add(tgt, idx, src, axis=0):
    return tgt.clone().index_add_(axis, idx, src)
def _segment_sum(src, seg, n):
    out = torch.zeros((n,) + src.shape[1:], dtype=src.dtype)
    return out.index_add_(0, seg, src)
def _pad(x, pw):
    flat = tuple(v for pair in reversed(pw) for v in pair)
    return torch.nn.functional.pad(x, flat)

kernel_name = 'concat_heads__grouped_kv_mqa__spectral_gfnet__prompt'

def setup_inputs():

    _w = (lambda a: (lambda t: t.to(torch.bfloat16) if t.is_floating_point() else t)(torch.as_tensor(a)))
    def _A_setup():
        B, S, D, H = 1, 2048, 640, 32
        Dh = D // H
        return {
            "x": _w((lambda *s: torch.randn(*s, dtype=torch.bfloat16) * 0.05)(B, S, D)),
            "wq": _w((lambda *s: torch.randn(*s, dtype=torch.bfloat16) * 0.8)(D, H * Dh)),
            "wk": _w((lambda *s: torch.randn(*s, dtype=torch.bfloat16) * 0.8)(D, Dh)),
            "wv": _w((lambda *s: torch.randn(*s, dtype=torch.bfloat16) * 0.05)(D, Dh)),
            "wo": _w((lambda *s: torch.randn(*s, dtype=torch.bfloat16) * 0.05)(H * Dh, D)),
        }
    _A_in = _A_setup()

    def _B_setup():
        B, S, D = 1, 2048, 640
        Df = D // 2 + 1
        return {
            "x": _w((lambda *s: torch.randn(*s, dtype=torch.bfloat16) * 0.05)(B, S, D)),
            "w_r": _w((lambda *s: torch.randn(*s, dtype=torch.bfloat16) * 1.6)(S, Df) * 0.02),
            "w_i": _w((lambda *s: torch.randn(*s, dtype=torch.bfloat16) * 1.6)(S, Df) * 0.02),
        }
    _B_in = _B_setup()

    return {
        "A_x": _A_in["x"],
        "A_wq": _A_in["wq"],
        "A_wk": _A_in["wk"],
        "A_wv": _A_in["wv"],
        "A_wo": _A_in["wo"],
        "B_x": _B_in["x"],
        "B_w_r": _B_in["w_r"],
        "B_w_i": _B_in["w_i"],
    }

def reference(A_x, A_wq, A_wk, A_wv, A_wo, B_x, B_w_r, B_w_i):
    def _A_ref(x, wq, wk, wv, wo):
        B, S, D = x.shape
        H = 32
        Dh = D // H
        q = (lambda x, *d: x.permute(*d))((x @ wq).reshape(B, S, H, Dh), 0, 2, 1, 3)
        k = x @ wk
        v = x @ wv
        scores = torch.einsum("bhqd,bkd->bhqk", q, k) * (Dh ** -0.5)
        p = _softmax(scores, axis=-1)
        o = torch.einsum("bhqk,bkd->bhqd", p, v)
        return (lambda x, *d: x.permute(*d))(o, 0, 2, 1, 3).reshape(B, S, H * Dh) @ wo

    def _B_ref(x, w_r, w_i):
        B, S, D = x.shape
        X = (lambda x, axes=(-2,-1): torch.fft.rfft2(x.float(), dim=axes))(x, axes=(-2, -1))
        W = w_r + 1j * w_i
        X = X * W
        y = (lambda x, s, axes=(-2,-1): torch.fft.irfft2(x, s=s, dim=axes).to(torch.bfloat16))(X, (S, D), axes=(-2, -1))
        return y

    a = _A_ref(A_x, A_wq, A_wk, A_wv, A_wo)
    b = _B_ref(B_x, B_w_r, B_w_i)
    return torch.concatenate([a, b], axis=-1)
```

```asm
; @launch grid=(256,1,1) block=(768,1,1) lds=163840
.amdgcn_target "amdgcn-amd-amdhsa--gfx950"
.text
.globl concat_heads__grouped_kv_mqa__spectral_gfnet__prompt_kernel
.p2align 8
.type concat_heads__grouped_kv_mqa__spectral_gfnet__prompt_kernel,@function
concat_heads__grouped_kv_mqa__spectral_gfnet__prompt_kernel:
    s_cmp_ge_u32 s2, 256
    s_cbranch_scc1 Lend
    s_load_dwordx16 s[4:19], s[0:1], 0
    s_load_dwordx2 s[20:21], s[0:1], 80
    s_load_dwordx4 s[40:43], s[0:1], 64
    v_lshrrev_b32 v2, 6, v0
    v_and_b32 v1, 63, v0
    v_readfirstlane_b32 s22, v2
    s_and_b32 s3, s2, 7
    s_lshl_b32 s3, s3, 5
    s_bfe_u32 s23, s2, 0x20003
    s_lshl_b32 s23, s23, 3
    s_add_u32 s3, s3, s23
    s_lshr_b32 s23, s2, 5
    s_add_u32 s23, s23, s3
    v_lshlrev_b32 v5, 4, v1
    s_lshr_b32 s65, s23, 3
    s_and_b32 s64, s23, 7
    s_cmp_lt_u32 s22, 8
    s_cbranch_scc1 Lattn_1
    s_sub_u32 s47, s22, 8
    s_and_b32 s58, s47, 1
    s_lshr_b32 s59, s47, 1
    s_cmp_ge_u32 s47, 2
    s_cbranch_scc1 Lrowfft_2
    v_lshrrev_b32 v2, 4, v1
    v_and_b32 v3, 15, v1
    v_add_u32 v4, 0, v2
    v_xor_b32 v6, v4, v3
    v_mul_u32_u24 v4, 1280, v4
    v_lshl_add_u32 v4, v6, 4, v4
    v_subrev_u32 v16, 0, v4
    v_add_u32 v4, 4, v2
    v_xor_b32 v6, v4, v3
    v_mul_u32_u24 v4, 1280, v4
    v_lshl_add_u32 v4, v6, 4, v4
    v_subrev_u32 v17, 1024, v4
    v_add_u32 v4, 8, v2
    v_xor_b32 v6, v4, v3
    v_mul_u32_u24 v4, 1280, v4
    v_lshl_add_u32 v4, v6, 4, v4
    v_subrev_u32 v18, 2048, v4
    v_add_u32 v4, 12, v2
    v_xor_b32 v6, v4, v3
    v_mul_u32_u24 v4, 1280, v4
    v_lshl_add_u32 v4, v6, 4, v4
    v_subrev_u32 v19, 3072, v4
    s_waitcnt lgkmcnt(0)
    s_mov_b32 s32, s20
    s_mov_b32 s33, s21
    s_mov_b32 s34, 14286848
    s_mov_b32 s35, 0x20000
    s_mov_b32 s24, s4
    s_mov_b32 s25, s5
    s_mov_b32 s26, 2621440
    s_mov_b32 s27, 0x20000
    s_cmp_ge_u32 s64, 2
    s_cselect_b32 s28, s10, s8
    s_cselect_b32 s29, s11, s9
    s_mov_b32 s30, 25600
    s_mov_b32 s31, 0x20000
    s_and_b32 s68, s64, 1
    s_lshl_b32 s68, s68, 1
    s_add_u32 s68, s68, s47
    s_lshl_b32 s69, s68, 12
    s_lshl_b32 s60, s65, 2
    s_add_u32 s68, s68, s60
    s_mul_i32 s68, s68, 20480
    s_add_u32 m0, s69, 0
    s_add_u32 s60, s68, 0
    buffer_load_dwordx4 v16, s[24:27], s60 offen offset:0 lds
    buffer_load_dwordx4 v17, s[24:27], s60 offen offset:1024 lds
    buffer_load_dwordx4 v18, s[24:27], s60 offen offset:2048 lds
    buffer_load_dwordx4 v19, s[24:27], s60 offen offset:3072 lds
    s_add_u32 m0, s69, 16384
    s_add_u32 s60, s68, 256
    buffer_load_dwordx4 v16, s[24:27], s60 offen offset:0 lds
    buffer_load_dwordx4 v17, s[24:27], s60 offen offset:1024 lds
    buffer_load_dwordx4 v18, s[24:27], s60 offen offset:2048 lds
    buffer_load_dwordx4 v19, s[24:27], s60 offen offset:3072 lds
    s_add_u32 m0, s69, 99328
    s_add_u32 s60, s68, 512
    buffer_load_dwordx4 v16, s[24:27], s60 offen offset:0 lds
    buffer_load_dwordx4 v17, s[24:27], s60 offen offset:1024 lds
    buffer_load_dwordx4 v18, s[24:27], s60 offen offset:2048 lds
    buffer_load_dwordx4 v19, s[24:27], s60 offen offset:3072 lds
    s_cmp_ge_u32 s64, 4
    s_cbranch_scc1 Lnowkv_4
    s_lshl_b32 s61, s47, 11
    s_add_u32 m0, s61, 43008
    s_add_u32 s60, s61, 0
    buffer_load_dwordx4 v5, s[28:31], s60 offen offset:0 lds
    buffer_load_dwordx4 v5, s[28:31], s60 offen offset:1024 lds
    buffer_load_dwordx4 v5, s[28:31], s60 offen offset:2048 lds
    s_add_u32 m0, s61, 48128
    s_add_u32 s60, s61, 5120
    buffer_load_dwordx4 v5, s[28:31], s60 offen offset:0 lds
    buffer_load_dwordx4 v5, s[28:31], s60 offen offset:1024 lds
    buffer_load_dwordx4 v5, s[28:31], s60 offen offset:2048 lds
    s_add_u32 m0, s61, 53248
    s_add_u32 s60, s61, 10240
    buffer_load_dwordx4 v5, s[28:31], s60 offen offset:0 lds
    buffer_load_dwordx4 v5, s[28:31], s60 offen offset:1024 lds
    buffer_load_dwordx4 v5, s[28:31], s60 offen offset:2048 lds
Lnowkv_4:
    s_add_u32 m0, s69, 125952
    s_add_u32 s60, s68, 768
    buffer_load_dwordx4 v16, s[24:27], s60 offen offset:0 lds
    buffer_load_dwordx4 v17, s[24:27], s60 offen offset:1024 lds
    buffer_load_dwordx4 v18, s[24:27], s60 offen offset:2048 lds
    buffer_load_dwordx4 v19, s[24:27], s60 offen offset:3072 lds
    s_add_u32 m0, s69, 142336
    s_add_u32 s60, s68, 1024
    buffer_load_dwordx4 v16, s[24:27], s60 offen offset:0 lds
    buffer_load_dwordx4 v17, s[24:27], s60 offen offset:1024 lds
    buffer_load_dwordx4 v18, s[24:27], s60 offen offset:2048 lds
    buffer_load_dwordx4 v19, s[24:27], s60 offen offset:3072 lds
    s_cmp_ge_u32 s64, 4
    s_cbranch_scc1 Lnowkv_5
    s_lshl_b32 s61, s47, 11
    s_add_u32 m0, s61, 58368
    s_add_u32 s60, s61, 15360
    buffer_load_dwordx4 v5, s[28:31], s60 offen offset:0 lds
    buffer_load_dwordx4 v5, s[28:31], s60 offen offset:1024 lds
    buffer_load_dwordx4 v5, s[28:31], s60 offen offset:2048 lds
    s_add_u32 m0, s61, 63488
    s_add_u32 s60, s61, 20480
    buffer_load_dwordx4 v5, s[28:31], s60 offen offset:0 lds
    buffer_load_dwordx4 v5, s[28:31], s60 offen offset:1024 lds
    buffer_load_dwordx4 v5, s[28:31], s60 offen offset:2048 lds
Lnowkv_5:
    v_add_u32 v2, 0, v1
    v_mul_u32_u24 v3, 820, v2
    v_lshrrev_b32 v3, 16, v3
    v_mul_u32_u24 v3, 39680, v3
    v_lshl_add_u32 v20, v2, 4, v3
    v_add_u32 v2, 64, v1
    v_mul_u32_u24 v3, 820, v2
    v_lshrrev_b32 v3, 16, v3
    v_mul_u32_u24 v3, 39680, v3
    v_subrev_u32 v2, 64, v2
    v_lshl_add_u32 v21, v2, 4, v3
    v_add_u32 v2, 128, v1
    v_mul_u32_u24 v3, 820, v2
    v_lshrrev_b32 v3, 16, v3
    v_mul_u32_u24 v3, 39680, v3
    v_subrev_u32 v2, 128, v2
    v_lshl_add_u32 v22, v2, 4, v3
    v_add_u32 v2, 192, v1
    v_mul_u32_u24 v3, 820, v2
    v_lshrrev_b32 v3, 16, v3
    v_mul_u32_u24 v3, 39680, v3
    v_subrev_u32 v2, 192, v2
    v_lshl_add_u32 v23, v2, 4, v3
    v_add_u32 v2, 256, v1
    v_mul_u32_u24 v3, 820, v2
    v_lshrrev_b32 v3, 16, v3
    v_mul_u32_u24 v3, 39680, v3
    v_lshl_add_u32 v24, v2, 4, v3
    s_mul_i32 s60, s64, 160
    v_add_u32 v9, 0, v1
    v_mul_u32_u24 v10, 6554, v9
    v_lshrrev_b32 v10, 16, v10
    v_mul_u32_u24 v11, 10, v10
    v_sub_u32 v9, v9, v11
    v_and_b32 v11, 1, v10
    v_bfe_u32 v12, v10, 1, 2
    v_lshl_or_b32 v11, v11, 2, v12
    v_and_b32 v10, 0xf8, v10
    v_or_b32 v10, v10, v11
    v_mul_u32_u24 v10, 1280, v10
    v_lshl_add_u32 v9, v9, 4, v10
    v_add_u32 v2, s60, v9
    v_add_u32 v9, 64, v1
    v_mul_u32_u24 v10, 6554, v9
    v_lshrrev_b32 v10, 16, v10
    v_mul_u32_u24 v11, 10, v10
    v_sub_u32 v9, v9, v11
    v_and_b32 v11, 1, v10
    v_bfe_u32 v12, v10, 1, 2
    v_lshl_or_b32 v11, v11, 2, v12
    v_and_b32 v10, 0xf8, v10
    v_or_b32 v10, v10, v11
    v_mul_u32_u24 v10, 1280, v10
    v_lshl_add_u32 v9, v9, 4, v10
    v_subrev_u32 v9, 1024, v9
    v_add_u32 v3, s60, v9
    v_add_u32 v9, 128, v1
    v_mul_u32_u24 v10, 6554, v9
    v_lshrrev_b32 v10, 16, v10
    v_mul_u32_u24 v11, 10, v10
    v_sub_u32 v9, v9, v11
    v_and_b32 v11, 1, v10
    v_bfe_u32 v12, v10, 1, 2
    v_lshl_or_b32 v11, v11, 2, v12
    v_and_b32 v10, 0xf8, v10
    v_or_b32 v10, v10, v11
    v_mul_u32_u24 v10, 1280, v10
    v_lshl_add_u32 v9, v9, 4, v10
    v_subrev_u32 v9, 2048, v9
    v_add_u32 v4, s60, v9
    v_add_u32 v9, 192, v1
    v_mul_u32_u24 v10, 6554, v9
    v_lshrrev_b32 v10, 16, v10
    v_mul_u32_u24 v11, 10, v10
    v_sub_u32 v9, v9, v11
    v_and_b32 v11, 1, v10
    v_bfe_u32 v12, v10, 1, 2
    v_lshl_or_b32 v11, v11, 2, v12
    v_and_b32 v10, 0xf8, v10
    v_or_b32 v10, v10, v11
    v_mul_u32_u24 v10, 1280, v10
    v_lshl_add_u32 v9, v9, 4, v10
    v_subrev_u32 v9, 3072, v9
    v_add_u32 v6, s60, v9
    v_add_u32 v9, 256, v1
    v_mul_u32_u24 v10, 6554, v9
    v_lshrrev_b32 v10, 16, v10
    v_mul_u32_u24 v11, 10, v10
    v_sub_u32 v9, v9, v11
    v_and_b32 v11, 1, v10
    v_bfe_u32 v12, v10, 1, 2
    v_lshl_or_b32 v11, v11, 2, v12
    v_and_b32 v10, 0xf8, v10
    v_or_b32 v10, v10, v11
    v_mul_u32_u24 v10, 1280, v10
    v_lshl_add_u32 v9, v9, 4, v10
    v_add_u32 v7, s60, v9
    s_mov_b32 s28, s6
    s_mov_b32 s29, s7
    s_mov_b32 s30, 819200
    s_mov_b32 s31, 0x20000
    s_and_b32 s68, s64, 1
    s_xor_b32 s68, s68, 1
    s_lshl_b32 s68, s68, 1
    s_add_u32 s68, s68, s47
    s_lshl_b32 s69, s68, 12
    s_lshl_b32 s60, s65, 2
    s_add_u32 s68, s68, s60
    s_mul_i32 s68, s68, 20480
    s_add_u32 m0, s69, 0
    s_add_u32 s60, s68, 0
    buffer_load_dwordx4 v16, s[24:27], s60 offen offset:0 lds
    buffer_load_dwordx4 v17, s[24:27], s60 offen offset:1024 lds
    buffer_load_dwordx4 v18, s[24:27], s60 offen offset:2048 lds
    buffer_load_dwordx4 v19, s[24:27], s60 offen offset:3072 lds
    s_add_u32 m0, s69, 16384
    s_add_u32 s60, s68, 256
    buffer_load_dwordx4 v16, s[24:27], s60 offen offset:0 lds
    buffer_load_dwordx4 v17, s[24:27], s60 offen offset:1024 lds
    buffer_load_dwordx4 v18, s[24:27], s60 offen offset:2048 lds
    buffer_load_dwordx4 v19, s[24:27], s60 offen offset:3072 lds
    s_mov_b32 s36, s14
    s_mov_b32 s37, s15
    s_mov_b32 s38, 2621440
    s_mov_b32 s39, 0x20000
    s_lshl_b32 s61, s23, 1
    s_add_u32 s61, s61, s47
    s_lshr_b32 s60, s61, 5
    s_lshl_b32 s60, s60, 7
    s_and_b32 s61, s61, 31
    s_add_u32 s60, s60, s61
    s_mul_i32 s60, s60, 1280
    s_mul_i32 s61, s47, 5120
    s_add_u32 s61, s61, 32768
    s_mov_b32 m0, s61
    s_nop 0
    buffer_load_dwordx4 v20, s[36:39], s60 offen offset:0 lds
    buffer_load_dwordx4 v21, s[36:39], s60 offen offset:1024 lds
    buffer_load_dwordx4 v22, s[36:39], s60 offen offset:2048 lds
    buffer_load_dwordx4 v23, s[36:39], s60 offen offset:3072 lds
    s_add_u32 m0, m0, 4096
    s_nop 0
    buffer_load_dwordx4 v24, s[36:39], s60 offen lds
    s_waitcnt vmcnt(27)
    s_barrier
    s_add_u32 s60, s47, 0
    s_mul_i32 s60, s60, 40960
    s_mul_i32 s61, s47, 5120
    s_add_u32 s61, s61, 78848
    s_mov_b32 m0, s61
    s_nop 0
    buffer_load_dwordx4 v2, s[28:31], s60 offen offset:0 lds
    buffer_load_dwordx4 v3, s[28:31], s60 offen offset:1024 lds
    buffer_load_dwordx4 v4, s[28:31], s60 offen offset:2048 lds
    buffer_load_dwordx4 v6, s[28:31], s60 offen offset:3072 lds
    s_add_u32 m0, m0, 4096
    s_nop 0
    buffer_load_dwordx4 v7, s[28:31], s60 offen lds
    s_add_u32 s60, s47, 2
    s_mul_i32 s60, s60, 40960
    s_mul_i32 s61, s47, 5120
    s_add_u32 s61, s61, 89088
    s_mov_b32 m0, s61
    s_nop 0
    buffer_load_dwordx4 v2, s[28:31], s60 offen offset:0 lds
    buffer_load_dwordx4 v3, s[28:31], s60 offen offset:1024 lds
    buffer_load_dwordx4 v4, s[28:31], s60 offen offset:2048 lds
    buffer_load_dwordx4 v6, s[28:31], s60 offen offset:3072 lds
    s_add_u32 m0, m0, 4096
    s_nop 0
    buffer_load_dwordx4 v7, s[28:31], s60 offen lds
    s_waitcnt vmcnt(23)
    s_barrier
    s_barrier
    s_setprio 3
    s_add_u32 m0, s69, 99328
    s_add_u32 s60, s68, 512
    buffer_load_dwordx4 v16, s[24:27], s60 offen offset:0 lds
    buffer_load_dwordx4 v17, s[24:27], s60 offen offset:1024 lds
    buffer_load_dwordx4 v18, s[24:27], s60 offen offset:2048 lds
    buffer_load_dwordx4 v19, s[24:27], s60 offen offset:3072 lds
    s_add_u32 s60, s47, 4
    s_mul_i32 s60, s60, 40960
    s_mul_i32 s61, s47, 5120
    s_add_u32 s61, s61, 68608
    s_mov_b32 m0, s61
    s_nop 0
    buffer_load_dwordx4 v2, s[28:31], s60 offen offset:0 lds
    buffer_load_dwordx4 v3, s[28:31], s60 offen offset:1024 lds
    buffer_load_dwordx4 v4, s[28:31], s60 offen offset:2048 lds
    buffer_load_dwordx4 v6, s[28:31], s60 offen offset:3072 lds
    s_add_u32 m0, m0, 4096
    s_nop 0
    buffer_load_dwordx4 v7, s[28:31], s60 offen lds
    s_add_u32 s60, s47, 6
    s_mul_i32 s60, s60, 40960
    s_mul_i32 s61, s47, 5120
    s_add_u32 s61, s61, 115712
    s_mov_b32 m0, s61
    s_nop 0
    buffer_load_dwordx4 v2, s[28:31], s60 offen offset:0 lds
    buffer_load_dwordx4 v3, s[28:31], s60 offen offset:1024 lds
    buffer_load_dwordx4 v4, s[28:31], s60 offen offset:2048 lds
    buffer_load_dwordx4 v6, s[28:31], s60 offen offset:3072 lds
    s_add_u32 m0, m0, 4096
    s_nop 0
    buffer_load_dwordx4 v7, s[28:31], s60 offen lds
    s_waitcnt vmcnt(14)
    s_barrier
    s_add_u32 m0, s69, 125952
    s_add_u32 s60, s68, 768
    buffer_load_dwordx4 v16, s[24:27], s60 offen offset:0 lds
    buffer_load_dwordx4 v17, s[24:27], s60 offen offset:1024 lds
    buffer_load_dwordx4 v18, s[24:27], s60 offen offset:2048 lds
    buffer_load_dwordx4 v19, s[24:27], s60 offen offset:3072 lds
    s_add_u32 s60, s47, 8
    s_mul_i32 s60, s60, 40960
    s_mul_i32 s61, s47, 5120
    s_add_u32 s61, s61, 43008
    s_mov_b32 m0, s61
    s_nop 0
    buffer_load_dwordx4 v2, s[28:31], s60 offen offset:0 lds
    buffer_load_dwordx4 v3, s[28:31], s60 offen offset:1024 lds
    buffer_load_dwordx4 v4, s[28:31], s60 offen offset:2048 lds
    buffer_load_dwordx4 v6, s[28:31], s60 offen offset:3072 lds
    s_add_u32 m0, m0, 4096
    s_nop 0
    buffer_load_dwordx4 v7, s[28:31], s60 offen lds
    s_add_u32 s60, s47, 10
    s_mul_i32 s60, s60, 40960
    s_mul_i32 s61, s47, 5120
    s_add_u32 s61, s61, 53248
    s_mov_b32 m0, s61
    s_nop 0
    buffer_load_dwordx4 v2, s[28:31], s60 offen offset:0 lds
    buffer_load_dwordx4 v3, s[28:31], s60 offen offset:1024 lds
    buffer_load_dwordx4 v4, s[28:31], s60 offen offset:2048 lds
    buffer_load_dwordx4 v6, s[28:31], s60 offen offset:3072 lds
    s_add_u32 m0, m0, 4096
    s_nop 0
    buffer_load_dwordx4 v7, s[28:31], s60 offen lds
    s_waitcnt vmcnt(14)
    s_barrier
    s_cmp_eq_u32 s47, 1
    s_cbranch_scc1 Lw9_6
    s_add_u32 m0, s69, 142336
    s_add_u32 s60, s68, 1024
    buffer_load_dwordx4 v16, s[24:27], s60 offen offset:0 lds
    buffer_load_dwordx4 v17, s[24:27], s60 offen offset:1024 lds
    buffer_load_dwordx4 v18, s[24:27], s60 offen offset:2048 lds
    buffer_load_dwordx4 v19, s[24:27], s60 offen offset:3072 lds
    s_add_u32 s60, s47, 12
    s_mul_i32 s60, s60, 40960
    s_mul_i32 s61, s47, 5120
    s_add_u32 s61, s61, 78848
    s_mov_b32 m0, s61
    s_nop 0
    buffer_load_dwordx4 v2, s[28:31], s60 offen offset:0 lds
    buffer_load_dwordx4 v3, s[28:31], s60 offen offset:1024 lds
    buffer_load_dwordx4 v4, s[28:31], s60 offen offset:2048 lds
    buffer_load_dwordx4 v6, s[28:31], s60 offen offset:3072 lds
    s_add_u32 m0, m0, 4096
    s_nop 0
    buffer_load_dwordx4 v7, s[28:31], s60 offen lds
    s_mov_b32 s47, 1
    s_add_u32 s68, s68, 20480
    s_add_u32 s69, s69, 4096
    s_add_u32 m0, s69, 142336
    s_add_u32 s60, s68, 1024
    buffer_load_dwordx4 v16, s[24:27], s60 offen offset:0 lds
    buffer_load_dwordx4 v17, s[24:27], s60 offen offset:1024 lds
    buffer_load_dwordx4 v18, s[24:27], s60 offen offset:2048 lds
    buffer_load_dwordx4 v19, s[24:27], s60 offen offset:3072 lds
    s_add_u32 s60, s47, 12
    s_mul_i32 s60, s60, 40960
    s_mul_i32 s61, s47, 5120
    s_add_u32 s61, s61, 78848
    s_mov_b32 m0, s61
    s_nop 0
    buffer_load_dwordx4 v2, s[28:31], s60 offen offset:0 lds
    buffer_load_dwordx4 v3, s[28:31], s60 offen offset:1024 lds
    buffer_load_dwordx4 v4, s[28:31], s60 offen offset:2048 lds
    buffer_load_dwordx4 v6, s[28:31], s60 offen offset:3072 lds
    s_add_u32 m0, m0, 4096
    s_nop 0
    buffer_load_dwordx4 v7, s[28:31], s60 offen lds
    s_mov_b32 s47, 0
    s_add_u32 s60, s47, 14
    s_mul_i32 s60, s60, 40960
    s_mul_i32 s61, s47, 5120
    s_add_u32 s61, s61, 89088
    s_mov_b32 m0, s61
    s_nop 0
    buffer_load_dwordx4 v2, s[28:31], s60 offen offset:0 lds
    buffer_load_dwordx4 v3, s[28:31], s60 offen offset:1024 lds
    buffer_load_dwordx4 v4, s[28:31], s60 offen offset:2048 lds
    buffer_load_dwordx4 v6, s[28:31], s60 offen offset:3072 lds
    s_add_u32 m0, m0, 4096
    s_nop 0
    buffer_load_dwordx4 v7, s[28:31], s60 offen lds
    s_mov_b32 s47, 1
    s_add_u32 s68, s68, 20480
    s_add_u32 s69, s69, 4096
    s_add_u32 s60, s47, 14
    s_mul_i32 s60, s60, 40960
    s_mul_i32 s61, s47, 5120
    s_add_u32 s61, s61, 89088
    s_mov_b32 m0, s61
    s_nop 0
    buffer_load_dwordx4 v2, s[28:31], s60 offen offset:0 lds
    buffer_load_dwordx4 v3, s[28:31], s60 offen offset:1024 lds
    buffer_load_dwordx4 v4, s[28:31], s60 offen offset:2048 lds
    buffer_load_dwordx4 v6, s[28:31], s60 offen offset:3072 lds
    s_add_u32 m0, m0, 4096
    s_nop 0
    buffer_load_dwordx4 v7, s[28:31], s60 offen lds
    s_mov_b32 s47, 0
    s_waitcnt vmcnt(28)
    s_barrier
    s_lshr_b32 s69, s23, 5
    s_lshl_b32 s69, s69, 12
    s_add_u32 s69, s69, 14221312
    v_lshlrev_b32 v28, 3, v1
    s_mov_b32 s67, s69
    s_add_u32 s60, s47, 16
    s_mul_i32 s60, s60, 40960
    s_mul_i32 s61, s47, 5120
    s_add_u32 s61, s61, 0
    s_mov_b32 m0, s61
    s_nop 0
    buffer_load_dwordx4 v2, s[28:31], s60 offen offset:0 lds
    buffer_load_dwordx4 v3, s[28:31], s60 offen offset:1024 lds
    buffer_load_dwordx4 v4, s[28:31], s60 offen offset:2048 lds
    buffer_load_dwordx4 v6, s[28:31], s60 offen offset:3072 lds
    s_add_u32 m0, m0, 4096
    s_nop 0
    buffer_load_dwordx4 v7, s[28:31], s60 offen lds
    s_mov_b32 s47, 1
    s_add_u32 s68, s68, 20480
    s_add_u32 s69, s69, 4096
    s_add_u32 s60, s47, 16
    s_mul_i32 s60, s60, 40960
    s_mul_i32 s61, s47, 5120
    s_add_u32 s61, s61, 0
    s_mov_b32 m0, s61
    s_nop 0
    buffer_load_dwordx4 v2, s[28:31], s60 offen offset:0 lds
    buffer_load_dwordx4 v3, s[28:31], s60 offen offset:1024 lds
    buffer_load_dwordx4 v4, s[28:31], s60 offen offset:2048 lds
    buffer_load_dwordx4 v6, s[28:31], s60 offen offset:3072 lds
    s_add_u32 m0, m0, 4096
    s_nop 0
    buffer_load_dwordx4 v7, s[28:31], s60 offen lds
    s_mov_b32 s47, 0
    s_add_u32 s60, s47, 18
    s_mul_i32 s60, s60, 40960
    s_mul_i32 s61, s47, 5120
    s_add_u32 s61, s61, 10240
    s_mov_b32 m0, s61
    s_nop 0
    buffer_load_dwordx4 v2, s[28:31], s60 offen offset:0 lds
    buffer_load_dwordx4 v3, s[28:31], s60 offen offset:1024 lds
    buffer_load_dwordx4 v4, s[28:31], s60 offen offset:2048 lds
    buffer_load_dwordx4 v6, s[28:31], s60 offen offset:3072 lds
    s_add_u32 m0, m0, 4096
    s_nop 0
    buffer_load_dwordx4 v7, s[28:31], s60 offen lds
    s_mov_b32 s47, 1
    s_add_u32 s68, s68, 20480
    s_add_u32 s69, s69, 4096
    s_add_u32 s60, s47, 18
    s_mul_i32 s60, s60, 40960
    s_mul_i32 s61, s47, 5120
    s_add_u32 s61, s61, 10240
    s_mov_b32 m0, s61
    s_nop 0
    buffer_load_dwordx4 v2, s[28:31], s60 offen offset:0 lds
    buffer_load_dwordx4 v3, s[28:31], s60 offen offset:1024 lds
    buffer_load_dwordx4 v4, s[28:31], s60 offen offset:2048 lds
    buffer_load_dwordx4 v6, s[28:31], s60 offen offset:3072 lds
    s_add_u32 m0, m0, 4096
    s_nop 0
    buffer_load_dwordx4 v7, s[28:31], s60 offen lds
    s_mov_b32 s47, 0
    s_mov_b32 s69, s67
    buffer_load_dwordx2 v[30:31], v28, s[32:35], s69 offen sc1
    v_mov_b32 v12, 158720
    ds_read_b32 v12, v12
    s_waitcnt lgkmcnt(0)
    v_readfirstlane_b32 s66, v12
    v_mov_b32 v12, 158728
    v_mov_b32 v13, 1
    s_waitcnt vmcnt(31)
    ds_write_b32 v12, v13
    v_mov_b32 v13, 2
    s_waitcnt vmcnt(21)
    ds_write_b32 v12, v13
    v_mov_b32 v13, 3
    s_waitcnt vmcnt(11)
    ds_write_b32 v12, v13
    v_mov_b32 v13, 4
    s_waitcnt vmcnt(1)
    ds_write_b32 v12, v13
    s_mov_b32 s44, 400000
    s_branch Lpck_10
Lpoll_8:
    buffer_load_dwordx2 v[30:31], v28, s[32:35], s69 offen sc1
Lpck_10:
    s_waitcnt vmcnt(0)
    v_xor_b32 v30, s66, v30
    v_xor_b32 v31, s66, v31
    v_or_b32 v30, v30, v31
    v_cmp_ne_u32 vcc, 0, v30
    s_nop 1
    s_cmp_lg_u64 vcc, 0
    s_cbranch_scc0 Lpok_9
    s_sub_u32 s44, s44, 1
    s_cbranch_scc0 Lpoll_8
Lpok_9:
    s_mov_b32 m0, 99328
    s_mov_b32 s60, 13500416
    buffer_load_dwordx4 v5, s[32:35], s60 offen offset:0 sc1 lds
    buffer_load_dwordx4 v5, s[32:35], s60 offen offset:1024 sc1 lds
    buffer_load_dwordx4 v5, s[32:35], s60 offen offset:2048 sc1 lds
    buffer_load_dwordx4 v5, s[32:35], s60 offen offset:3072 sc1 lds
    s_add_u32 m0, m0, 4096
    s_add_u32 s60, s60, 4096
    buffer_load_dwordx4 v5, s[32:35], s60 offen offset:0 sc1 lds
    buffer_load_dwordx4 v5, s[32:35], s60 offen offset:1024 sc1 lds
    buffer_load_dwordx4 v5, s[32:35], s60 offen offset:2048 sc1 lds
    buffer_load_dwordx4 v5, s[32:35], s60 offen offset:3072 sc1 lds
    s_add_u32 m0, m0, 4096
    s_add_u32 s60, s60, 4096
    buffer_load_dwordx4 v5, s[32:35], s60 offen offset:0 sc1 lds
    buffer_load_dwordx4 v5, s[32:35], s60 offen offset:1024 sc1 lds
    buffer_load_dwordx4 v5, s[32:35], s60 offen offset:2048 sc1 lds
    buffer_load_dwordx4 v5, s[32:35], s60 offen offset:3072 sc1 lds
    s_add_u32 m0, m0, 4096
    s_add_u32 s60, s60, 4096
    buffer_load_dwordx4 v5, s[32:35], s60 offen offset:0 sc1 lds
    buffer_load_dwordx4 v5, s[32:35], s60 offen offset:1024 sc1 lds
    buffer_load_dwordx4 v5, s[32:35], s60 offen offset:2048 sc1 lds
    buffer_load_dwordx4 v5, s[32:35], s60 offen offset:3072 sc1 lds
    s_add_u32 m0, m0, 4096
    s_add_u32 s60, s60, 4096
    buffer_load_dwordx4 v5, s[32:35], s60 offen offset:0 sc1 lds
    buffer_load_dwordx4 v5, s[32:35], s60 offen offset:1024 sc1 lds
    buffer_load_dwordx4 v5, s[32:35], s60 offen offset:2048 sc1 lds
    buffer_load_dwordx4 v5, s[32:35], s60 offen offset:3072 sc1 lds
    s_add_u32 m0, m0, 4096
    s_add_u32 s60, s60, 4096
    buffer_load_dwordx4 v5, s[32:35], s60 offen offset:0 sc1 lds
    s_mov_b32 s24, s16
    s_mov_b32 s25, s17
    s_mov_b32 s26, 1314816
    s_mov_b32 s27, 0x20000
    s_mov_b32 s36, s18
    s_mov_b32 s37, s19
    s_mov_b32 s38, 1314816
    s_mov_b32 s39, 0x20000
    v_lshlrev_b32 v2, 1, v1
    s_mov_b32 exec_hi, 0x1ff
    s_lshl_b32 s60, s23, 1
    s_add_u32 s60, s60, 0
    s_lshr_b32 s61, s60, 6
    s_lshl_b32 s61, s61, 8
    s_and_b32 s60, s60, 63
    s_add_u32 s60, s60, s61
    s_mul_i32 s60, s60, 642
    s_and_b32 s68, s60, 15
    s_sub_u32 s60, s60, s68
    s_add_u32 s68, s68, 63488
    s_mov_b32 s50, s68
    s_mov_b32 m0, 63488
    s_nop 0
    buffer_load_dwordx4 v5, s[24:27], s60 offen lds
    s_mov_b32 m0, 68736
    s_nop 0
    buffer_load_dwordx4 v5, s[36:39], s60 offen lds
    s_add_u32 s60, s60, 41088
    s_mov_b32 m0, 64144
    s_nop 0
    buffer_load_dwordx4 v5, s[24:27], s60 offen lds
    s_mov_b32 m0, 69392
    s_nop 0
    buffer_load_dwordx4 v5, s[36:39], s60 offen lds
    s_add_u32 s60, s60, 41088
    s_mov_b32 m0, 64800
    s_nop 0
    buffer_load_dwordx4 v5, s[24:27], s60 offen lds
    s_mov_b32 m0, 70048
    s_nop 0
    buffer_load_dwordx4 v5, s[36:39], s60 offen lds
    s_add_u32 s60, s60, 41088
    s_mov_b32 m0, 65456
    s_nop 0
    buffer_load_dwordx4 v5, s[24:27], s60 offen lds
    s_mov_b32 m0, 70704
    s_nop 0
    buffer_load_dwordx4 v5, s[36:39], s60 offen lds
    s_add_u32 s60, s60, 41088
    s_lshl_b32 s60, s23, 1
    s_add_u32 s60, s60, 1
    s_lshr_b32 s61, s60, 6
    s_lshl_b32 s61, s61, 8
    s_and_b32 s60, s60, 63
    s_add_u32 s60, s60, s61
    s_mul_i32 s60, s60, 642
    s_and_b32 s68, s60, 15
    s_sub_u32 s60, s60, s68
    s_add_u32 s68, s68, 66112
    s_mov_b32 s51, s68
    s_mov_b32 m0, 66112
    s_nop 0
    buffer_load_dwordx4 v5, s[24:27], s60 offen lds
    s_mov_b32 m0, 71360
    s_nop 0
    buffer_load_dwordx4 v5, s[36:39], s60 offen lds
    s_add_u32 s60, s60, 41088
    s_mov_b32 m0, 66768
    s_nop 0
    buffer_load_dwordx4 v5, s[24:27], s60 offen lds
    s_mov_b32 m0, 72016
    s_nop 0
    buffer_load_dwordx4 v5, s[36:39], s60 offen lds
    s_add_u32 s60, s60, 41088
    s_mov_b32 m0, 67424
    s_nop 0
    buffer_load_dwordx4 v5, s[24:27], s60 offen lds
    s_mov_b32 m0, 72672
    s_nop 0
    buffer_load_dwordx4 v5, s[36:39], s60 offen lds
    s_add_u32 s60, s60, 41088
    s_mov_b32 m0, 68080
    s_nop 0
    buffer_load_dwordx4 v5, s[24:27], s60 offen lds
    s_mov_b32 m0, 73328
    s_nop 0
    buffer_load_dwordx4 v5, s[36:39], s60 offen lds
    s_add_u32 s60, s60, 41088
    s_mov_b32 exec_hi, -1
    v_add_u32 v20, s50, v2
    v_add_u32 v21, s51, v2
    s_waitcnt vmcnt(16) lgkmcnt(0)
    s_branch Ljoin_7
Lw9_6:
    v_mov_b32 v12, 158720
    ds_read_b32 v12, v12
    s_waitcnt lgkmcnt(0)
    v_readfirstlane_b32 s66, v12
    s_waitcnt vmcnt(0)
    s_barrier
Ljoin_7:
    s_branch Lb0_3
Lrowfft_2:
    s_setprio 3
    s_waitcnt lgkmcnt(0)
    s_mov_b32 s32, s20
    s_mov_b32 s33, s21
    s_mov_b32 s34, 14286848
    s_mov_b32 s35, 0x20000
    s_mov_b32 s36, s42
    s_mov_b32 s37, s43
    s_mov_b32 s38, 4
    s_mov_b32 s39, 0x20000
    s_cmp_lg_u32 s23, 0
    s_cbranch_scc1 Ln0_11
    s_cmp_lg_u32 s47, 3
    s_cbranch_scc1 Ln0_11
    s_memrealtime s[66:67]
    v_mov_b32 v2, 0
    s_waitcnt lgkmcnt(0)
    s_or_b32 s66, s66, 1
    v_mov_b32 v3, s66
    s_mov_b64 exec, 1
    buffer_store_dword v3, v2, s[36:39], 0 offen sc1
    s_mov_b64 exec, -1
Ln0_11:
    s_lshl_b32 s54, s65, 2
    s_add_u32 s54, s54, s64
    s_lshl_b32 s44, s54, 1
    s_add_u32 s44, s44, s58
    s_cmp_ge_u32 s64, 4
    s_cselect_b32 s44, 999, s44
    s_cmp_ge_u32 s44, 68
    s_cbranch_scc1 Lnotab_12
    s_mov_b32 s48, 2
    s_mov_b32 s49, 1.0
    s_cmp_ge_u32 s44, 64
    s_cbranch_scc1 Lk_14
    s_cmp_ge_u32 s44, 56
    s_cbranch_scc1 Lk_15
    s_cmp_ge_u32 s44, 40
    s_cbranch_scc1 Lk_16
    s_cmp_ge_u32 s44, 32
    s_cbranch_scc1 Lk_17
    s_lshr_b32 s60, s44, 4
    s_bfe_u32 s61, s44, 0x10003
    s_and_b32 s68, s44, 7
    s_mov_b32 s69, 0x3c800000
    s_branch Lgo_13
Lk_17:
    s_mov_b32 s60, 0
    s_bfe_u32 s61, s44, 0x10002
    s_and_b32 s68, s44, 3
    s_mov_b32 s69, 0x3d000000
    s_branch Lgo_13
Lk_16:
    s_sub_u32 s68, s44, 40
    s_lshr_b32 s60, s68, 3
    s_bfe_u32 s61, s68, 0x10002
    s_mul_i32 s61, s61, 3
    s_and_b32 s68, s68, 3
    s_mov_b32 s69, 0x3a000000
    s_branch Lgo_13
Lk_15:
    s_mov_b32 s60, 0
    s_bfe_u32 s61, s44, 0x10002
    s_mul_i32 s61, s61, 3
    s_and_b32 s68, s44, 3
    s_mov_b32 s69, 0x3acccccd
    s_branch Lgo_13
Lk_14:
    s_mov_b32 s60, 0
    s_and_b32 s61, s44, 1
    s_bfe_u32 s68, s44, 0x10001
    s_sub_u32 s48, 2, s68
    s_mov_b32 s69, 0xbd4ccccd
    s_mov_b32 s49, 0x35cccccd
Lgo_13:
    s_lshl_b32 s60, s60, 5
    s_lshl_b32 s68, s68, 3
    v_and_b32 v140, 31, v1
    v_add_u32 v140, s60, v140
    v_lshrrev_b32 v141, 5, v1
    v_lshlrev_b32 v141, s48, v141
    v_add_u32 v141, s68, v141
    v_cvt_f32_u32 v140, v140
    v_cvt_f32_u32 v141, v141
    v_cvt_f32_u32 v142, s61
    v_mul_f32 v140, s69, v140
    v_mul_f32 v142, 0x3e800000, v142
    v_fmac_f32 v142, v140, v141
    v_fract_f32 v143, v142
    v_cos_f32 v144, v143
    v_sin_f32 v148, v143
    v_add_f32 v142, v142, v140
    v_fract_f32 v143, v142
    v_cos_f32 v145, v143
    v_sin_f32 v149, v143
    v_add_f32 v142, v142, v140
    v_fract_f32 v143, v142
    v_cos_f32 v146, v143
    v_sin_f32 v150, v143
    v_add_f32 v142, v142, v140
    v_fract_f32 v143, v142
    v_cos_f32 v147, v143
    v_sin_f32 v151, v143
    v_add_f32 v142, v142, v140
    v_mul_f32 v144, s49, v144
    v_mul_f32 v145, s49, v145
    v_mul_f32 v146, s49, v146
    v_mul_f32 v147, s49, v147
    v_mul_f32 v148, s49, v148
    v_mul_f32 v149, s49, v149
    v_mul_f32 v150, s49, v150
    v_mul_f32 v151, s49, v151
    s_sub_u32 s60, s44, 40
    s_cmp_lt_u32 s60, 24
    s_cbranch_scc1 Lnocvt_18
    v_cvt_pk_bf16_f32 v144, v144, v148
    v_cvt_pk_bf16_f32 v145, v145, v149
    v_cvt_pk_bf16_f32 v146, v146, v150
    v_cvt_pk_bf16_f32 v147, v147, v151
Lnocvt_18:
    s_lshl_b32 s60, s44, 10
    s_add_u32 s60, s60, 13762560
    buffer_store_dwordx4 v[144:147], v5, s[32:35], s60 offen sc1
Lnotab_12:
    v_and_b32 v4, 31, v1
    v_lshrrev_b32 v6, 5, v1
    v_cvt_f32_u32 v9, v4
    v_cvt_f32_u32 v10, v6
    v_mul_f32 v7, 0x3d000000, v9
    v_mul_f32 v11, 0x41000000, v10
    v_mul_f32 v11, v11, v7
    v_fmamk_f32 v72, v7, 0x00000000, v11
    v_fract_f32 v73, v72
    v_cos_f32 v76, v73
    v_sin_f32 v84, v73
    v_fmamk_f32 v72, v7, 0x3f800000, v11
    v_fract_f32 v73, v72
    v_cos_f32 v77, v73
    v_sin_f32 v85, v73
    v_fmamk_f32 v72, v7, 0x40000000, v11
    v_fract_f32 v73, v72
    v_cos_f32 v78, v73
    v_sin_f32 v86, v73
    v_fmamk_f32 v72, v7, 0x40400000, v11
    v_fract_f32 v73, v72
    v_cos_f32 v79, v73
    v_sin_f32 v87, v73
    v_fmamk_f32 v72, v7, 0x40800000, v11
    v_fract_f32 v73, v72
    v_cos_f32 v80, v73
    v_sin_f32 v88, v73
    v_fmamk_f32 v72, v7, 0x40a00000, v11
    v_fract_f32 v73, v72
    v_cos_f32 v81, v73
    v_sin_f32 v89, v73
    v_fmamk_f32 v72, v7, 0x40c00000, v11
    v_fract_f32 v73, v72
    v_cos_f32 v82, v73
    v_sin_f32 v90, v73
    v_fmamk_f32 v72, v7, 0x40e00000, v11
    v_fract_f32 v73, v72
    v_cos_f32 v83, v73
    v_sin_f32 v91, v73
    s_nop 0
    v_cvt_pk_bf16_f32 v12, v76, v77
    v_cvt_pk_bf16_f32 v20, -v84, -v85
    v_cvt_pk_bf16_f32 v13, v78, v79
    v_cvt_pk_bf16_f32 v21, -v86, -v87
    v_cvt_pk_bf16_f32 v14, v80, v81
    v_cvt_pk_bf16_f32 v22, -v88, -v89
    v_cvt_pk_bf16_f32 v15, v82, v83
    v_cvt_pk_bf16_f32 v23, -v90, -v91
    v_fmamk_f32 v72, v7, 0x41800000, v11
    v_fract_f32 v73, v72
    v_cos_f32 v76, v73
    v_sin_f32 v84, v73
    v_fmamk_f32 v72, v7, 0x41880000, v11
    v_fract_f32 v73, v72
    v_cos_f32 v77, v73
    v_sin_f32 v85, v73
    v_fmamk_f32 v72, v7, 0x41900000, v11
    v_fract_f32 v73, v72
    v_cos_f32 v78, v73
    v_sin_f32 v86, v73
    v_fmamk_f32 v72, v7, 0x41980000, v11
    v_fract_f32 v73, v72
    v_cos_f32 v79, v73
    v_sin_f32 v87, v73
    v_fmamk_f32 v72, v7, 0x41a00000, v11
    v_fract_f32 v73, v72
    v_cos_f32 v80, v73
    v_sin_f32 v88, v73
    v_fmamk_f32 v72, v7, 0x41a80000, v11
    v_fract_f32 v73, v72
    v_cos_f32 v81, v73
    v_sin_f32 v89, v73
    v_fmamk_f32 v72, v7, 0x41b00000, v11
    v_fract_f32 v73, v72
    v_cos_f32 v82, v73
    v_sin_f32 v90, v73
    v_fmamk_f32 v72, v7, 0x41b80000, v11
    v_fract_f32 v73, v72
    v_cos_f32 v83, v73
    v_sin_f32 v91, v73
    s_nop 0
    v_cvt_pk_bf16_f32 v16, v76, v77
    v_cvt_pk_bf16_f32 v24, -v84, -v85
    v_cvt_pk_bf16_f32 v17, v78, v79
    v_cvt_pk_bf16_f32 v25, -v86, -v87
    v_cvt_pk_bf16_f32 v18, v80, v81
    v_cvt_pk_bf16_f32 v26, -v88, -v89
    v_cvt_pk_bf16_f32 v19, v82, v83
    v_cvt_pk_bf16_f32 v27, -v90, -v91
    v_mul_f32 v7, 0x3acccccd, v9
    v_mul_f32 v11, 4.0, v10
    v_mul_f32 v11, v11, v7
    v_fmamk_f32 v72, v7, 0x00000000, v11
    v_cos_f32 v28, v72
    v_sin_f32 v40, v72
    v_fmamk_f32 v72, v7, 0x3f800000, v11
    v_cos_f32 v29, v72
    v_sin_f32 v41, v72
    v_fmamk_f32 v72, v7, 0x40000000, v11
    v_cos_f32 v30, v72
    v_sin_f32 v42, v72
    v_fmamk_f32 v72, v7, 0x40400000, v11
    v_cos_f32 v31, v72
    v_sin_f32 v43, v72
    v_fmamk_f32 v72, v7, 0x41000000, v11
    v_cos_f32 v32, v72
    v_sin_f32 v44, v72
    v_fmamk_f32 v72, v7, 0x41100000, v11
    v_cos_f32 v33, v72
    v_sin_f32 v45, v72
    v_fmamk_f32 v72, v7, 0x41200000, v11
    v_cos_f32 v34, v72
    v_sin_f32 v46, v72
    v_fmamk_f32 v72, v7, 0x41300000, v11
    v_cos_f32 v35, v72
    v_sin_f32 v47, v72
    v_fmamk_f32 v72, v7, 0x41800000, v11
    v_cos_f32 v36, v72
    v_sin_f32 v48, v72
    v_fmamk_f32 v72, v7, 0x41880000, v11
    v_cos_f32 v37, v72
    v_sin_f32 v49, v72
    v_fmamk_f32 v72, v7, 0x41900000, v11
    v_cos_f32 v38, v72
    v_sin_f32 v50, v72
    v_fmamk_f32 v72, v7, 0x41980000, v11
    v_cos_f32 v39, v72
    v_sin_f32 v51, v72
    v_mov_b32 v164, 0
    buffer_load_dword v165, v164, s[36:39], 0 offen sc1
    s_barrier
    v_lshrrev_b32 v7, 1, v4
    v_cvt_f32_u32 v7, v7
    v_mul_f32 v7, 0x3d4ccccd, v7
    v_and_b32 v9, 1, v4
    v_cvt_f32_u32 v9, v9
    v_mul_f32 v11, 4.0, v10
    v_mul_f32 v11, v11, v7
    v_fmac_f32 v11, 0x3e800000, v9
    v_fmamk_f32 v72, v7, 0x00000000, v11
    v_fract_f32 v73, v72
    v_cos_f32 v76, v73
    v_sin_f32 v77, v73
    v_fmamk_f32 v72, v7, 0x3f800000, v11
    v_fract_f32 v73, v72
    v_cos_f32 v78, v73
    v_sin_f32 v79, v73
    v_fmamk_f32 v72, v7, 0x40000000, v11
    v_fract_f32 v73, v72
    v_cos_f32 v80, v73
    v_sin_f32 v81, v73
    v_fmamk_f32 v72, v7, 0x40400000, v11
    v_fract_f32 v73, v72
    v_cos_f32 v82, v73
    v_sin_f32 v83, v73
    v_fmamk_f32 v72, v7, 0x41000000, v11
    v_fract_f32 v73, v72
    v_cos_f32 v84, v73
    v_sin_f32 v85, v73
    v_fmamk_f32 v72, v7, 0x41100000, v11
    v_fract_f32 v73, v72
    v_cos_f32 v86, v73
    v_sin_f32 v87, v73
    v_fmamk_f32 v72, v7, 0x41200000, v11
    v_fract_f32 v73, v72
    v_cos_f32 v88, v73
    v_sin_f32 v89, v73
    v_fmamk_f32 v72, v7, 0x41300000, v11
    v_fract_f32 v73, v72
    v_cos_f32 v90, v73
    v_sin_f32 v91, v73
    v_fmamk_f32 v72, v7, 0x41800000, v11
    v_fract_f32 v73, v72
    v_cos_f32 v92, v73
    v_sin_f32 v93, v73
    v_fmamk_f32 v72, v7, 0x41880000, v11
    v_fract_f32 v73, v72
    v_cos_f32 v94, v73
    v_sin_f32 v95, v73
    v_fmamk_f32 v72, v7, 0x41900000, v11
    v_fract_f32 v73, v72
    v_cos_f32 v96, v73
    v_sin_f32 v97, v73
    v_fmamk_f32 v72, v7, 0x41980000, v11
    v_fract_f32 v73, v72
    v_cos_f32 v98, v73
    v_sin_f32 v99, v73
    s_nop 0
    v_cvt_pk_bf16_f32 v52, v76, v77
    v_cvt_pk_bf16_f32 v53, v78, v79
    v_cvt_pk_bf16_f32 v54, v80, v81
    v_cvt_pk_bf16_f32 v55, v82, v83
    v_cvt_pk_bf16_f32 v56, v84, v85
    v_cvt_pk_bf16_f32 v57, v86, v87
    v_cvt_pk_bf16_f32 v58, v88, v89
    v_cvt_pk_bf16_f32 v59, v90, v91
    v_cvt_pk_bf16_f32 v60, v92, v93
    v_cvt_pk_bf16_f32 v61, v94, v95
    v_cvt_pk_bf16_f32 v62, v96, v97
    v_cvt_pk_bf16_f32 v63, v98, v99
    s_mov_b32 exec_lo, 0
    v_mov_b32 v60, 0
    v_mov_b32 v61, 0
    v_mov_b32 v62, 0
    v_mov_b32 v63, 0
    s_mov_b32 exec_lo, -1
    s_mul_i32 s68, s58, 5120
    s_add_u32 s68, s68, 32768
    v_and_b32 v9, 15, v1
    v_lshrrev_b32 v10, 2, v9
    v_lshl_add_u32 v10, v6, 3, v10
    v_mul_u32_u24 v10, 40, v10
    v_and_b32 v9, 3, v1
    v_lshlrev_b32 v9, 3, v9
    v_and_b32 v11, 16, v1
    v_cmp_ne_u32 vcc, 0, v11
    v_mov_b32 v11, 32
    s_nop 0
    v_cndmask_b32 v9, v9, v11, vcc
    v_add3_u32 v2, v9, v10, s68
    v_lshlrev_b32 v9, 4, v4
    v_lshl_add_u32 v3, v6, 10, v9
    s_barrier
    s_cmp_lg_u32 s47, 3
    s_cbranch_scc1 Lnotag_19
    s_mov_b32 s44, 400000
    s_branch Ltagck_22
Ltag_20:
    buffer_load_dword v165, v164, s[36:39], 0 offen sc1
Ltagck_22:
    s_waitcnt vmcnt(0)
    v_readfirstlane_b32 s66, v165
    s_sub_u32 s44, s44, 1
    s_cbranch_scc1 Ltagok_21
    s_cmp_eq_u32 s66, 0
    s_cbranch_scc1 Ltag_20
Ltagok_21:
    v_mov_b32 v9, 158720
    v_mov_b32 v10, v165
    v_mov_b32 v11, 0
    ds_write_b64 v9, v[10:11]
    ds_write_b32 v9, v11 offset:8
Lnotag_19:
    s_waitcnt vmcnt(0) lgkmcnt(0)
    s_barrier
    s_barrier
    ds_read_b64_tr_b16 v[64:65], v2 offset:0
    ds_read_b64_tr_b16 v[66:67], v2 offset:160
    ds_read_b64_tr_b16 v[68:69], v2 offset:640
    ds_read_b64_tr_b16 v[70:71], v2 offset:800
    s_waitcnt lgkmcnt(0)
    v_mfma_f32_32x32x16_bf16 v[76:91], v[64:67], v[12:15], 0
    v_mfma_f32_32x32x16_bf16 v[92:107], v[64:67], v[20:23], 0
    v_mfma_f32_32x32x16_bf16 v[76:91], v[68:71], v[16:19], v[76:91]
    v_mfma_f32_32x32x16_bf16 v[92:107], v[68:71], v[24:27], v[92:107]
    ds_read_b64_tr_b16 v[64:65], v2 offset:1280
    ds_read_b64_tr_b16 v[66:67], v2 offset:1440
    ds_read_b64_tr_b16 v[68:69], v2 offset:1920
    ds_read_b64_tr_b16 v[70:71], v2 offset:2080
    s_barrier
    s_waitcnt lgkmcnt(0)
    v_mfma_f32_32x32x16_bf16 v[108:123], v[64:67], v[12:15], 0
    v_mfma_f32_32x32x16_bf16 v[124:139], v[64:67], v[20:23], 0
    v_mfma_f32_32x32x16_bf16 v[108:123], v[68:71], v[16:19], v[108:123]
    v_mfma_f32_32x32x16_bf16 v[124:139], v[68:71], v[24:27], v[124:139]
    ds_read_b64_tr_b16 v[64:65], v2 offset:2560
    ds_read_b64_tr_b16 v[66:67], v2 offset:2720
    ds_read_b64_tr_b16 v[68:69], v2 offset:3200
    ds_read_b64_tr_b16 v[70:71], v2 offset:3360
    s_nop 2
    v_mul_f32 v72, v76, v28
    v_mul_f32 v74, v92, v28
    v_mul_f32 v73, v77, v29
    v_mul_f32 v75, v93, v29
    v_fmac_f32 v72, v92, v40
    v_fma_f32 v74, -v76, v40, v74
    v_fmac_f32 v73, v93, v41
    v_fma_f32 v75, -v77, v41, v75
    v_cvt_pk_bf16_f32 v76, v72, v74
    v_cvt_pk_bf16_f32 v77, v73, v75
    v_mul_f32 v72, v78, v30
    v_mul_f32 v74, v94, v30
    v_mul_f32 v73, v79, v31
    v_mul_f32 v75, v95, v31
    v_fmac_f32 v72, v94, v42
    v_fma_f32 v74, -v78, v42, v74
    v_fmac_f32 v73, v95, v43
    v_fma_f32 v75, -v79, v43, v75
    v_cvt_pk_bf16_f32 v78, v72, v74
    v_cvt_pk_bf16_f32 v79, v73, v75
    v_mul_f32 v72, v80, v32
    v_mul_f32 v74, v96, v32
    v_mul_f32 v73, v81, v33
    v_mul_f32 v75, v97, v33
    v_fmac_f32 v72, v96, v44
    v_fma_f32 v74, -v80, v44, v74
    v_fmac_f32 v73, v97, v45
    v_fma_f32 v75, -v81, v45, v75
    v_cvt_pk_bf16_f32 v80, v72, v74
    v_cvt_pk_bf16_f32 v81, v73, v75
    v_mul_f32 v72, v82, v34
    v_mul_f32 v74, v98, v34
    v_mul_f32 v73, v83, v35
    v_mul_f32 v75, v99, v35
    v_fmac_f32 v72, v98, v46
    v_fma_f32 v74, -v82, v46, v74
    v_fmac_f32 v73, v99, v47
    v_fma_f32 v75, -v83, v47, v75
    v_cvt_pk_bf16_f32 v82, v72, v74
    v_cvt_pk_bf16_f32 v83, v73, v75
    v_mul_f32 v72, v84, v36
    v_mul_f32 v74, v100, v36
    v_mul_f32 v73, v85, v37
    v_mul_f32 v75, v101, v37
    v_fmac_f32 v72, v100, v48
    v_fma_f32 v74, -v84, v48, v74
    v_fmac_f32 v73, v101, v49
    v_fma_f32 v75, -v85, v49, v75
    v_cvt_pk_bf16_f32 v84, v72, v74
    v_cvt_pk_bf16_f32 v85, v73, v75
    v_mul_f32 v72, v86, v38
    v_mul_f32 v74, v102, v38
    v_mul_f32 v73, v87, v39
    v_mul_f32 v75, v103, v39
    v_fmac_f32 v72, v102, v50
    v_fma_f32 v74, -v86, v50, v74
    v_fmac_f32 v73, v103, v51
    v_fma_f32 v75, -v87, v51, v75
    v_cvt_pk_bf16_f32 v86, v72, v74
    v_cvt_pk_bf16_f32 v87, v73, v75
    s_barrier
    s_nop 0
    v_mfma_f32_32x32x16_bf16 v[92:107], v[52:55], v[76:79], 0
    v_mfma_f32_32x32x16_bf16 v[92:107], v[56:59], v[80:83], v[92:107]
    v_mfma_f32_32x32x16_bf16 v[92:107], v[60:63], v[84:87], v[92:107]
    v_mul_f32 v72, v108, v28
    v_mul_f32 v74, v124, v28
    v_mul_f32 v73, v109, v29
    v_mul_f32 v75, v125, v29
    v_fmac_f32 v72, v124, v40
    v_fma_f32 v74, -v108, v40, v74
    v_fmac_f32 v73, v125, v41
    v_fma_f32 v75, -v109, v41, v75
    v_cvt_pk_bf16_f32 v108, v72, v74
    v_cvt_pk_bf16_f32 v109, v73, v75
    v_mul_f32 v72, v110, v30
    v_mul_f32 v74, v126, v30
    v_mul_f32 v73, v111, v31
    v_mul_f32 v75, v127, v31
    v_fmac_f32 v72, v126, v42
    v_fma_f32 v74, -v110, v42, v74
    v_fmac_f32 v73, v127, v43
    v_fma_f32 v75, -v111, v43, v75
    v_cvt_pk_bf16_f32 v110, v72, v74
    v_cvt_pk_bf16_f32 v111, v73, v75
    v_mul_f32 v72, v112, v32
    v_mul_f32 v74, v128, v32
    v_mul_f32 v73, v113, v33
    v_mul_f32 v75, v129, v33
    v_fmac_f32 v72, v128, v44
    v_fma_f32 v74, -v112, v44, v74
    v_fmac_f32 v73, v129, v45
    v_fma_f32 v75, -v113, v45, v75
    v_cvt_pk_bf16_f32 v112, v72, v74
    v_cvt_pk_bf16_f32 v113, v73, v75
    v_mul_f32 v72, v114, v34
    v_mul_f32 v74, v130, v34
    v_mul_f32 v73, v115, v35
    v_mul_f32 v75, v131, v35
    v_fmac_f32 v72, v130, v46
    v_fma_f32 v74, -v114, v46, v74
    v_fmac_f32 v73, v131, v47
    v_fma_f32 v75, -v115, v47, v75
    v_cvt_pk_bf16_f32 v114, v72, v74
    v_cvt_pk_bf16_f32 v115, v73, v75
    v_mul_f32 v72, v116, v36
    v_mul_f32 v74, v132, v36
    v_mul_f32 v73, v117, v37
    v_mul_f32 v75, v133, v37
    v_fmac_f32 v72, v132, v48
    v_fma_f32 v74, -v116, v48, v74
    v_fmac_f32 v73, v133, v49
    v_fma_f32 v75, -v117, v49, v75
    v_cvt_pk_bf16_f32 v116, v72, v74
    v_cvt_pk_bf16_f32 v117, v73, v75
    v_mul_f32 v72, v118, v38
    v_mul_f32 v74, v134, v38
    v_mul_f32 v73, v119, v39
    v_mul_f32 v75, v135, v39
    v_fmac_f32 v72, v134, v50
    v_fma_f32 v74, -v118, v50, v74
    v_fmac_f32 v73, v135, v51
    v_fma_f32 v75, -v119, v51, v75
    v_cvt_pk_bf16_f32 v118, v72, v74
    v_cvt_pk_bf16_f32 v119, v73, v75
    s_nop 1
    v_mfma_f32_32x32x16_bf16 v[124:139], v[52:55], v[108:111], 0
    v_mfma_f32_32x32x16_bf16 v[124:139], v[56:59], v[112:115], v[124:139]
    v_mfma_f32_32x32x16_bf16 v[124:139], v[60:63], v[116:119], v[124:139]
    v_cvt_pk_bf16_f32 v140, v92, v93
    v_cvt_pk_bf16_f32 v144, v94, v95
    v_cvt_pk_bf16_f32 v148, v96, v97
    v_cvt_pk_bf16_f32 v152, v98, v99
    v_cvt_pk_bf16_f32 v156, v100, v101
    v_cvt_pk_bf16_f32 v160, v102, v103
    s_waitcnt lgkmcnt(0)
    v_mfma_f32_32x32x16_bf16 v[76:91], v[64:67], v[12:15], 0
    v_mfma_f32_32x32x16_bf16 v[92:107], v[64:67], v[20:23], 0
    v_mfma_f32_32x32x16_bf16 v[76:91], v[68:71], v[16:19], v[76:91]
    v_mfma_f32_32x32x16_bf16 v[92:107], v[68:71], v[24:27], v[92:107]
    ds_read_b64_tr_b16 v[64:65], v2 offset:3840
    ds_read_b64_tr_b16 v[66:67], v2 offset:4000
    ds_read_b64_tr_b16 v[68:69], v2 offset:4480
    ds_read_b64_tr_b16 v[70:71], v2 offset:4640
    v_cvt_pk_bf16_f32 v141, v124, v125
    v_cvt_pk_bf16_f32 v145, v126, v127
    v_cvt_pk_bf16_f32 v149, v128, v129
    v_cvt_pk_bf16_f32 v153, v130, v131
    v_cvt_pk_bf16_f32 v157, v132, v133
    v_cvt_pk_bf16_f32 v161, v134, v135
    s_waitcnt lgkmcnt(0)
    v_mfma_f32_32x32x16_bf16 v[108:123], v[64:67], v[12:15], 0
    v_mfma_f32_32x32x16_bf16 v[124:139], v[64:67], v[20:23], 0
    v_mfma_f32_32x32x16_bf16 v[108:123], v[68:71], v[16:19], v[108:123]
    v_mfma_f32_32x32x16_bf16 v[124:139], v[68:71], v[24:27], v[124:139]
    v_mul_f32 v72, v76, v28
    v_mul_f32 v74, v92, v28
    v_mul_f32 v73, v77, v29
    v_mul_f32 v75, v93, v29
    v_fmac_f32 v72, v92, v40
    v_fma_f32 v74, -v76, v40, v74
    v_fmac_f32 v73, v93, v41
    v_fma_f32 v75, -v77, v41, v75
    v_cvt_pk_bf16_f32 v76, v72, v74
    v_cvt_pk_bf16_f32 v77, v73, v75
    v_mul_f32 v72, v78, v30
    v_mul_f32 v74, v94, v30
    v_mul_f32 v73, v79, v31
    v_mul_f32 v75, v95, v31
    v_fmac_f32 v72, v94, v42
    v_fma_f32 v74, -v78, v42, v74
    v_fmac_f32 v73, v95, v43
    v_fma_f32 v75, -v79, v43, v75
    v_cvt_pk_bf16_f32 v78, v72, v74
    v_cvt_pk_bf16_f32 v79, v73, v75
    v_mul_f32 v72, v80, v32
    v_mul_f32 v74, v96, v32
    v_mul_f32 v73, v81, v33
    v_mul_f32 v75, v97, v33
    v_fmac_f32 v72, v96, v44
    v_fma_f32 v74, -v80, v44, v74
    v_fmac_f32 v73, v97, v45
    v_fma_f32 v75, -v81, v45, v75
    v_cvt_pk_bf16_f32 v80, v72, v74
    v_cvt_pk_bf16_f32 v81, v73, v75
    v_mul_f32 v72, v82, v34
    v_mul_f32 v74, v98, v34
    v_mul_f32 v73, v83, v35
    v_mul_f32 v75, v99, v35
    v_fmac_f32 v72, v98, v46
    v_fma_f32 v74, -v82, v46, v74
    v_fmac_f32 v73, v99, v47
    v_fma_f32 v75, -v83, v47, v75
    v_cvt_pk_bf16_f32 v82, v72, v74
    v_cvt_pk_bf16_f32 v83, v73, v75
    v_mul_f32 v72, v84, v36
    v_mul_f32 v74, v100, v36
    v_mul_f32 v73, v85, v37
    v_mul_f32 v75, v101, v37
    v_fmac_f32 v72, v100, v48
    v_fma_f32 v74, -v84, v48, v74
    v_fmac_f32 v73, v101, v49
    v_fma_f32 v75, -v85, v49, v75
    v_cvt_pk_bf16_f32 v84, v72, v74
    v_cvt_pk_bf16_f32 v85, v73, v75
    v_mul_f32 v72, v86, v38
    v_mul_f32 v74, v102, v38
    v_mul_f32 v73, v87, v39
    v_mul_f32 v75, v103, v39
    v_fmac_f32 v72, v102, v50
    v_fma_f32 v74, -v86, v50, v74
    v_fmac_f32 v73, v103, v51
    v_fma_f32 v75, -v87, v51, v75
    v_cvt_pk_bf16_f32 v86, v72, v74
    v_cvt_pk_bf16_f32 v87, v73, v75
    s_nop 1
    v_mfma_f32_32x32x16_bf16 v[92:107], v[52:55], v[76:79], 0
    v_mfma_f32_32x32x16_bf16 v[92:107], v[56:59], v[80:83], v[92:107]
    v_mfma_f32_32x32x16_bf16 v[92:107], v[60:63], v[84:87], v[92:107]
    v_mul_f32 v72, v108, v28
    v_mul_f32 v74, v124, v28
    v_mul_f32 v73, v109, v29
    v_mul_f32 v75, v125, v29
    v_fmac_f32 v72, v124, v40
    v_fma_f32 v74, -v108, v40, v74
    v_fmac_f32 v73, v125, v41
    v_fma_f32 v75, -v109, v41, v75
    v_cvt_pk_bf16_f32 v108, v72, v74
    v_cvt_pk_bf16_f32 v109, v73, v75
    v_mul_f32 v72, v110, v30
    v_mul_f32 v74, v126, v30
    v_mul_f32 v73, v111, v31
    v_mul_f32 v75, v127, v31
    v_fmac_f32 v72, v126, v42
    v_fma_f32 v74, -v110, v42, v74
    v_fmac_f32 v73, v127, v43
    v_fma_f32 v75, -v111, v43, v75
    v_cvt_pk_bf16_f32 v110, v72, v74
    v_cvt_pk_bf16_f32 v111, v73, v75
    v_mul_f32 v72, v112, v32
    v_mul_f32 v74, v128, v32
    v_mul_f32 v73, v113, v33
    v_mul_f32 v75, v129, v33
    v_fmac_f32 v72, v128, v44
    v_fma_f32 v74, -v112, v44, v74
    v_fmac_f32 v73, v129, v45
    v_fma_f32 v75, -v113, v45, v75
    v_cvt_pk_bf16_f32 v112, v72, v74
    v_cvt_pk_bf16_f32 v113, v73, v75
    v_mul_f32 v72, v114, v34
    v_mul_f32 v74, v130, v34
    v_mul_f32 v73, v115, v35
    v_mul_f32 v75, v131, v35
    v_fmac_f32 v72, v130, v46
    v_fma_f32 v74, -v114, v46, v74
    v_fmac_f32 v73, v131, v47
    v_fma_f32 v75, -v115, v47, v75
    v_cvt_pk_bf16_f32 v114, v72, v74
    v_cvt_pk_bf16_f32 v115, v73, v75
    v_mul_f32 v72, v116, v36
    v_mul_f32 v74, v132, v36
    v_mul_f32 v73, v117, v37
    v_mul_f32 v75, v133, v37
    v_fmac_f32 v72, v132, v48
    v_fma_f32 v74, -v116, v48, v74
    v_fmac_f32 v73, v133, v49
    v_fma_f32 v75, -v117, v49, v75
    v_cvt_pk_bf16_f32 v116, v72, v74
    v_cvt_pk_bf16_f32 v117, v73, v75
    v_mul_f32 v72, v118, v38
    v_mul_f32 v74, v134, v38
    v_mul_f32 v73, v119, v39
    v_mul_f32 v75, v135, v39
    v_fmac_f32 v72, v134, v50
    v_fma_f32 v74, -v118, v50, v74
    v_fmac_f32 v73, v135, v51
    v_fma_f32 v75, -v119, v51, v75
    v_cvt_pk_bf16_f32 v118, v72, v74
    v_cvt_pk_bf16_f32 v119, v73, v75
    s_nop 1
    v_mfma_f32_32x32x16_bf16 v[124:139], v[52:55], v[108:111], 0
    v_mfma_f32_32x32x16_bf16 v[124:139], v[56:59], v[112:115], v[124:139]
    v_mfma_f32_32x32x16_bf16 v[124:139], v[60:63], v[116:119], v[124:139]
    v_cvt_pk_bf16_f32 v142, v92, v93
    v_cvt_pk_bf16_f32 v146, v94, v95
    v_cvt_pk_bf16_f32 v150, v96, v97
    v_cvt_pk_bf16_f32 v154, v98, v99
    v_cvt_pk_bf16_f32 v158, v100, v101
    v_cvt_pk_bf16_f32 v162, v102, v103
    s_nop 5
    v_cvt_pk_bf16_f32 v143, v124, v125
    v_cvt_pk_bf16_f32 v147, v126, v127
    v_cvt_pk_bf16_f32 v151, v128, v129
    v_cvt_pk_bf16_f32 v155, v130, v131
    v_cvt_pk_bf16_f32 v159, v132, v133
    v_cvt_pk_bf16_f32 v163, v134, v135
    s_lshl_b32 s60, s23, 1
    s_add_u32 s60, s60, s58
    s_mul_i32 s60, s60, 5248
    s_add_u32 s60, s60, 5242880
    s_add_u32 s61, s60, 4096
    buffer_store_dwordx4 v[140:143], v3, s[32:35], s60 offen offset:0 sc1
    buffer_store_dwordx4 v[144:147], v3, s[32:35], s60 offen offset:512 sc1
    buffer_store_dwordx4 v[148:151], v3, s[32:35], s60 offen offset:2048 sc1
    buffer_store_dwordx4 v[152:155], v3, s[32:35], s60 offen offset:2560 sc1
    s_mov_b32 exec_hi, 0xff
    buffer_store_dwordx4 v[156:159], v3, s[32:35], s61 offen offset:0 sc1
    s_mov_b32 exec_hi, 0
    buffer_store_dwordx4 v[160:163], v3, s[32:35], s61 offen offset:512 sc1
    s_mov_b32 exec_hi, -1
    v_mov_b32 v9, 158720
    ds_read_b32 v9, v9
    s_waitcnt lgkmcnt(0)
    v_readfirstlane_b32 s66, v9
Lb0_3:
    s_setprio 3
    s_mul_i32 s54, s47, 5120
    s_add_u32 s48, s54, 13521920
    s_mov_b32 s46, 120832
    v_mul_u32_u24 v8, 5248, v1
    s_mul_i32 s55, s65, 10
    s_add_u32 s55, s55, s64
    s_sub_u32 s60, s64, 4
    s_max_i32 s61, s60, 0
    s_min_u32 s61, s61, 2
    s_add_u32 s55, s55, s61
    s_cmp_eq_u32 s23, 255
    s_cselect_b32 s55, 320, s55
    s_cmp_lt_u32 s60, 2
    s_cselect_b32 s56, 1, 0
    s_cmp_eq_u32 s23, 254
    s_cselect_b32 s56, 1, s56
    s_add_u32 s57, s55, s59
    s_cmp_gt_u32 s59, s56
    s_cselect_b32 s57, 999, s57
    s_barrier
    s_add_u32 m0, s46, s54
    s_add_u32 s60, s48, 4096
    buffer_load_dwordx4 v5, s[32:35], s48 offen offset:0 sc1 lds
    buffer_load_dwordx4 v5, s[32:35], s48 offen offset:1024 sc1 lds
    buffer_load_dwordx4 v5, s[32:35], s48 offen offset:2048 sc1 lds
    buffer_load_dwordx4 v5, s[32:35], s48 offen offset:3072 sc1 lds
    s_add_u32 m0, m0, 4096
    s_add_u32 s48, s48, 21504
    buffer_load_dwordx4 v5, s[32:35], s60 offen offset:0 sc1 lds
    buffer_load_dwordx4 v5, s[32:35], s60 offen offset:1024 sc1 lds
    s_add_u32 s46, s46, 21504
    s_cmp_ge_u32 s46, 163840
    s_cselect_b32 s46, 99328, s46
    s_cmp_lg_u32 s47, 3
    s_cbranch_scc1 Lnopre_25
    v_mov_b32 v12, 0
    v_mov_b32 v13, 0
    v_mov_b32 v14, 0
    v_mov_b32 v15, 0
    s_mul_i32 s60, s64, 339200
    s_lshl_b32 s61, s65, 10
    s_add_u32 s60, s60, s61
    s_add_u32 s60, s60, 2368512
    s_add_u32 s61, s60, 33920
    buffer_store_dwordx4 v[12:15], v5, s[32:35], s60 offen sc1
    buffer_store_dwordx4 v[12:15], v5, s[32:35], s61 offen sc1
    s_lshl_b32 s60, s23, 7
    s_add_u32 s60, s60, 13893632
    s_mov_b64 exec, 0xff
    buffer_store_dwordx4 v[12:15], v5, s[32:35], s60 offen sc1
    s_mov_b64 exec, -1
Lnopre_25:
    s_add_u32 m0, s46, s54
    s_add_u32 s60, s48, 4096
    buffer_load_dwordx4 v5, s[32:35], s48 offen offset:0 sc1 lds
    buffer_load_dwordx4 v5, s[32:35], s48 offen offset:1024 sc1 lds
    buffer_load_dwordx4 v5, s[32:35], s48 offen offset:2048 sc1 lds
    buffer_load_dwordx4 v5, s[32:35], s48 offen offset:3072 sc1 lds
    s_add_u32 m0, m0, 4096
    s_add_u32 s48, s48, 21504
    buffer_load_dwordx4 v5, s[32:35], s60 offen offset:0 sc1 lds
    buffer_load_dwordx4 v5, s[32:35], s60 offen offset:1024 sc1 lds
    s_add_u32 s46, s46, 21504
    s_cmp_ge_u32 s46, 163840
    s_cselect_b32 s46, 99328, s46
    s_cmp_lg_u32 s47, 0
    s_cbranch_scc1 Ln8_27
    s_mul_i32 s60, s23, 10496
    s_add_u32 s60, s60, 7995392
    s_waitcnt vmcnt(12)
    ds_read_u16 v24, v20 offset:0
    ds_read_u16 v28, v20 offset:5248
    ds_read_u16 v25, v20 offset:656
    ds_read_u16 v29, v20 offset:5904
    ds_read_u16 v26, v20 offset:1312
    ds_read_u16 v30, v20 offset:6560
    ds_read_u16 v27, v20 offset:1968
    ds_read_u16 v31, v20 offset:7216
    ds_read_u16 v32, v20 offset:128
    ds_read_u16 v36, v20 offset:5376
    ds_read_u16 v33, v20 offset:784
    ds_read_u16 v37, v20 offset:6032
    ds_read_u16 v34, v20 offset:1440
    ds_read_u16 v38, v20 offset:6688
    ds_read_u16 v35, v20 offset:2096
    s_waitcnt lgkmcnt(7)
    ds_read_u16 v39, v20 offset:7344
    s_add_u32 s61, s60, 4096
    v_lshl_or_b32 v24, v28, 16, v24
    v_lshl_or_b32 v25, v29, 16, v25
    v_lshl_or_b32 v26, v30, 16, v26
    v_lshl_or_b32 v27, v31, 16, v27
    buffer_store_dwordx4 v[24:27], v5, s[32:35], s60 offen offset:0 sc1
    ds_read_u16 v40, v20 offset:256
    ds_read_u16 v44, v20 offset:5504
    ds_read_u16 v41, v20 offset:912
    ds_read_u16 v45, v20 offset:6160
    ds_read_u16 v42, v20 offset:1568
    ds_read_u16 v46, v20 offset:6816
    ds_read_u16 v43, v20 offset:2224
    s_waitcnt lgkmcnt(7)
    ds_read_u16 v47, v20 offset:7472
    v_lshl_or_b32 v32, v36, 16, v32
    v_lshl_or_b32 v33, v37, 16, v33
    v_lshl_or_b32 v34, v38, 16, v34
    v_lshl_or_b32 v35, v39, 16, v35
    buffer_store_dwordx4 v[32:35], v5, s[32:35], s60 offen offset:1024 sc1
    ds_read_u16 v24, v20 offset:384
    ds_read_u16 v28, v20 offset:5632
    ds_read_u16 v25, v20 offset:1040
    ds_read_u16 v29, v20 offset:6288
    ds_read_u16 v26, v20 offset:1696
    ds_read_u16 v30, v20 offset:6944
    ds_read_u16 v27, v20 offset:2352
    s_waitcnt lgkmcnt(7)
    ds_read_u16 v31, v20 offset:7600
    v_lshl_or_b32 v40, v44, 16, v40
    v_lshl_or_b32 v41, v45, 16, v41
    v_lshl_or_b32 v42, v46, 16, v42
    v_lshl_or_b32 v43, v47, 16, v43
    buffer_store_dwordx4 v[40:43], v5, s[32:35], s60 offen offset:2048 sc1
    ds_read_u16 v32, v20 offset:512
    ds_read_u16 v36, v20 offset:5760
    ds_read_u16 v33, v20 offset:1168
    ds_read_u16 v37, v20 offset:6416
    ds_read_u16 v34, v20 offset:1824
    ds_read_u16 v38, v20 offset:7072
    ds_read_u16 v35, v20 offset:2480
    s_waitcnt lgkmcnt(7)
    ds_read_u16 v39, v20 offset:7728
    v_lshl_or_b32 v24, v28, 16, v24
    v_lshl_or_b32 v25, v29, 16, v25
    v_lshl_or_b32 v26, v30, 16, v26
    v_lshl_or_b32 v27, v31, 16, v27
    buffer_store_dwordx4 v[24:27], v5, s[32:35], s60 offen offset:3072 sc1
    ds_read_u16 v40, v20 offset:640
    ds_read_u16 v44, v20 offset:5888
    ds_read_u16 v41, v20 offset:1296
    ds_read_u16 v45, v20 offset:6544
    ds_read_u16 v42, v20 offset:1952
    ds_read_u16 v46, v20 offset:7200
    ds_read_u16 v43, v20 offset:2608
    s_waitcnt lgkmcnt(7)
    ds_read_u16 v47, v20 offset:7856
    v_lshl_or_b32 v32, v36, 16, v32
    v_lshl_or_b32 v33, v37, 16, v33
    v_lshl_or_b32 v34, v38, 16, v34
    v_lshl_or_b32 v35, v39, 16, v35
    buffer_store_dwordx4 v[32:35], v5, s[32:35], s61 offen offset:0 sc1
    ds_read_u16 v24, v21 offset:0
    ds_read_u16 v28, v21 offset:5248
    ds_read_u16 v25, v21 offset:656
    ds_read_u16 v29, v21 offset:5904
    ds_read_u16 v26, v21 offset:1312
    ds_read_u16 v30, v21 offset:6560
    ds_read_u16 v27, v21 offset:1968
    s_waitcnt lgkmcnt(7)
    ds_read_u16 v31, v21 offset:7216
    v_lshl_or_b32 v40, v44, 16, v40
    v_lshl_or_b32 v41, v45, 16, v41
    v_lshl_or_b32 v42, v46, 16, v42
    v_lshl_or_b32 v43, v47, 16, v43
    s_mov_b64 exec, 0xff
    buffer_store_dwordx4 v[40:43], v5, s[32:35], s61 offen offset:1024 sc1
    s_mov_b64 exec, -1
    s_add_u32 s60, s60, 5248
    ds_read_u16 v32, v21 offset:128
    ds_read_u16 v36, v21 offset:5376
    ds_read_u16 v33, v21 offset:784
    ds_read_u16 v37, v21 offset:6032
    ds_read_u16 v34, v21 offset:1440
    ds_read_u16 v38, v21 offset:6688
    ds_read_u16 v35, v21 offset:2096
    s_waitcnt lgkmcnt(7)
    ds_read_u16 v39, v21 offset:7344
    s_add_u32 s61, s60, 4096
    v_lshl_or_b32 v24, v28, 16, v24
    v_lshl_or_b32 v25, v29, 16, v25
    v_lshl_or_b32 v26, v30, 16, v26
    v_lshl_or_b32 v27, v31, 16, v27
    buffer_store_dwordx4 v[24:27], v5, s[32:35], s60 offen offset:0 sc1
    ds_read_u16 v40, v21 offset:256
    ds_read_u16 v44, v21 offset:5504
    ds_read_u16 v41, v21 offset:912
    ds_read_u16 v45, v21 offset:6160
    ds_read_u16 v42, v21 offset:1568
    ds_read_u16 v46, v21 offset:6816
    ds_read_u16 v43, v21 offset:2224
    s_waitcnt lgkmcnt(7)
    ds_read_u16 v47, v21 offset:7472
    v_lshl_or_b32 v32, v36, 16, v32
    v_lshl_or_b32 v33, v37, 16, v33
    v_lshl_or_b32 v34, v38, 16, v34
    v_lshl_or_b32 v35, v39, 16, v35
    buffer_store_dwordx4 v[32:35], v5, s[32:35], s60 offen offset:1024 sc1
    ds_read_u16 v24, v21 offset:384
    ds_read_u16 v28, v21 offset:5632
    ds_read_u16 v25, v21 offset:1040
    ds_read_u16 v29, v21 offset:6288
    ds_read_u16 v26, v21 offset:1696
    ds_read_u16 v30, v21 offset:6944
    ds_read_u16 v27, v21 offset:2352
    s_waitcnt lgkmcnt(7)
    ds_read_u16 v31, v21 offset:7600
    v_lshl_or_b32 v40, v44, 16, v40
    v_lshl_or_b32 v41, v45, 16, v41
    v_lshl_or_b32 v42, v46, 16, v42
    v_lshl_or_b32 v43, v47, 16, v43
    buffer_store_dwordx4 v[40:43], v5, s[32:35], s60 offen offset:2048 sc1
    ds_read_u16 v32, v21 offset:512
    ds_read_u16 v36, v21 offset:5760
    ds_read_u16 v33, v21 offset:1168
    ds_read_u16 v37, v21 offset:6416
    ds_read_u16 v34, v21 offset:1824
    ds_read_u16 v38, v21 offset:7072
    ds_read_u16 v35, v21 offset:2480
    s_waitcnt lgkmcnt(7)
    ds_read_u16 v39, v21 offset:7728
    v_lshl_or_b32 v24, v28, 16, v24
    v_lshl_or_b32 v25, v29, 16, v25
    v_lshl_or_b32 v26, v30, 16, v26
    v_lshl_or_b32 v27, v31, 16, v27
    buffer_store_dwordx4 v[24:27], v5, s[32:35], s60 offen offset:3072 sc1
    ds_read_u16 v40, v21 offset:640
    ds_read_u16 v44, v21 offset:5888
    ds_read_u16 v41, v21 offset:1296
    ds_read_u16 v45, v21 offset:6544
    ds_read_u16 v42, v21 offset:1952
    ds_read_u16 v46, v21 offset:7200
    ds_read_u16 v43, v21 offset:2608
    s_waitcnt lgkmcnt(7)
    ds_read_u16 v47, v21 offset:7856
    v_lshl_or_b32 v32, v36, 16, v32
    v_lshl_or_b32 v33, v37, 16, v33
    v_lshl_or_b32 v34, v38, 16, v34
    v_lshl_or_b32 v35, v39, 16, v35
    buffer_store_dwordx4 v[32:35], v5, s[32:35], s61 offen offset:0 sc1
    s_waitcnt lgkmcnt(0)
    v_lshl_or_b32 v40, v44, 16, v40
    v_lshl_or_b32 v41, v45, 16, v41
    v_lshl_or_b32 v42, v46, 16, v42
    v_lshl_or_b32 v43, v47, 16, v43
    s_mov_b64 exec, 0xff
    buffer_store_dwordx4 v[40:43], v5, s[32:35], s61 offen offset:1024 sc1
    s_mov_b64 exec, -1
    s_add_u32 s60, s60, 5248
    s_waitcnt vmcnt(18)
    s_barrier
    s_add_u32 m0, s46, s54
    s_add_u32 s60, s48, 4096
    buffer_load_dwordx4 v5, s[32:35], s48 offen offset:0 sc1 lds
    buffer_load_dwordx4 v5, s[32:35], s48 offen offset:1024 sc1 lds
    buffer_load_dwordx4 v5, s[32:35], s48 offen offset:2048 sc1 lds
    buffer_load_dwordx4 v5, s[32:35], s48 offen offset:3072 sc1 lds
    s_add_u32 m0, m0, 4096
    s_add_u32 s48, s48, 21504
    buffer_load_dwordx4 v5, s[32:35], s60 offen offset:0 sc1 lds
    buffer_load_dwordx4 v5, s[32:35], s60 offen offset:1024 sc1 lds
    s_add_u32 s46, s46, 21504
    s_cmp_ge_u32 s46, 163840
    s_cselect_b32 s46, 99328, s46
    s_waitcnt vmcnt(6)
    s_lshl_b32 s60, s23, 2
    s_add_u32 s60, s60, 14188544
    v_lshlrev_b32 v9, 12, v1
    v_mov_b32 v10, s66
    s_mov_b64 exec, 255
    buffer_store_dword v10, v9, s[32:35], s60 offen sc1
    s_mov_b64 exec, -1
    s_branch Lb1_24
Ln8_27:
    s_waitcnt vmcnt(6)
    s_barrier
    s_sub_u32 s60, s47, 1
    s_mul_i32 s60, s60, 19456
    s_min_u32 s60, s60, 37888
    s_add_u32 s61, s60, 13762560
    s_add_u32 m0, s60, 0
    s_nop 0
    buffer_load_dwordx4 v5, s[32:35], s61 offen offset:0 sc1 lds
    buffer_load_dwordx4 v5, s[32:35], s61 offen offset:1024 sc1 lds
    buffer_load_dwordx4 v5, s[32:35], s61 offen offset:2048 sc1 lds
    buffer_load_dwordx4 v5, s[32:35], s61 offen offset:3072 sc1 lds
    s_add_u32 m0, m0, 4096
    s_add_u32 s61, s61, 4096
    buffer_load_dwordx4 v5, s[32:35], s61 offen offset:0 sc1 lds
    buffer_load_dwordx4 v5, s[32:35], s61 offen offset:1024 sc1 lds
    buffer_load_dwordx4 v5, s[32:35], s61 offen offset:2048 sc1 lds
    buffer_load_dwordx4 v5, s[32:35], s61 offen offset:3072 sc1 lds
    s_add_u32 m0, m0, 4096
    s_add_u32 s61, s61, 4096
    buffer_load_dwordx4 v5, s[32:35], s61 offen offset:0 sc1 lds
    buffer_load_dwordx4 v5, s[32:35], s61 offen offset:1024 sc1 lds
    buffer_load_dwordx4 v5, s[32:35], s61 offen offset:2048 sc1 lds
    buffer_load_dwordx4 v5, s[32:35], s61 offen offset:3072 sc1 lds
    s_add_u32 m0, m0, 4096
    s_add_u32 s61, s61, 4096
    buffer_load_dwordx4 v5, s[32:35], s61 offen offset:0 sc1 lds
    buffer_load_dwordx4 v5, s[32:35], s61 offen offset:1024 sc1 lds
    buffer_load_dwordx4 v5, s[32:35], s61 offen offset:2048 sc1 lds
    buffer_load_dwordx4 v5, s[32:35], s61 offen offset:3072 sc1 lds
    s_add_u32 m0, m0, 4096
    s_add_u32 s61, s61, 4096
    buffer_load_dwordx4 v5, s[32:35], s61 offen offset:0 sc1 lds
    buffer_load_dwordx4 v5, s[32:35], s61 offen offset:1024 sc1 lds
    buffer_load_dwordx4 v5, s[32:35], s61 offen offset:2048 sc1 lds
    s_add_u32 m0, s46, s54
    s_add_u32 s60, s48, 4096
    buffer_load_dwordx4 v5, s[32:35], s48 offen offset:0 sc1 lds
    buffer_load_dwordx4 v5, s[32:35], s48 offen offset:1024 sc1 lds
    buffer_load_dwordx4 v5, s[32:35], s48 offen offset:2048 sc1 lds
    buffer_load_dwordx4 v5, s[32:35], s48 offen offset:3072 sc1 lds
    s_add_u32 m0, m0, 4096
    s_add_u32 s48, s48, 21504
    buffer_load_dwordx4 v5, s[32:35], s60 offen offset:0 sc1 lds
    buffer_load_dwordx4 v5, s[32:35], s60 offen offset:1024 sc1 lds
    s_add_u32 s46, s46, 21504
    s_cmp_ge_u32 s46, 163840
    s_cselect_b32 s46, 99328, s46
    s_branch Lb1_24
Lw8_23:
    s_lshl_b32 s60, s23, 2
    s_add_u32 s60, s60, 14188544
    v_lshlrev_b32 v9, 12, v1
    v_mov_b32 v10, s66
    s_mov_b64 exec, 255
    buffer_store_dword v10, v9, s[32:35], s60 offen sc1
    s_mov_b64 exec, -1
    s_add_u32 m0, s46, s54
    s_add_u32 s60, s48, 4096
    buffer_load_dwordx4 v5, s[32:35], s48 offen offset:0 sc1 lds
    buffer_load_dwordx4 v5, s[32:35], s48 offen offset:1024 sc1 lds
    buffer_load_dwordx4 v5, s[32:35], s48 offen offset:2048 sc1 lds
    buffer_load_dwordx4 v5, s[32:35], s48 offen offset:3072 sc1 lds
    s_add_u32 m0, m0, 4096
    s_add_u32 s48, s48, 21504
    buffer_load_dwordx4 v5, s[32:35], s60 offen offset:0 sc1 lds
    buffer_load_dwordx4 v5, s[32:35], s60 offen offset:1024 sc1 lds
    s_add_u32 s46, s46, 21504
    s_cmp_ge_u32 s46, 163840
    s_cselect_b32 s46, 99328, s46
Lb1_24:
    s_mov_b32 s28, s12
    s_mov_b32 s29, s13
    s_mov_b32 s30, 819200
    s_mov_b32 s31, 0x20000
    s_mul_i32 s60, s64, 160
    v_add_u32 v9, 0, v1
    v_mul_u32_u24 v10, 6554, v9
    v_lshrrev_b32 v10, 16, v10
    v_mul_u32_u24 v11, 10, v10
    v_sub_u32 v9, v9, v11
    v_mul_u32_u24 v10, 1280, v10
    v_lshl_add_u32 v9, v9, 4, v10
    v_add_u32 v2, s60, v9
    v_add_u32 v9, 64, v1
    v_mul_u32_u24 v10, 6554, v9
    v_lshrrev_b32 v10, 16, v10
    v_mul_u32_u24 v11, 10, v10
    v_sub_u32 v9, v9, v11
    v_mul_u32_u24 v10, 1280, v10
    v_lshl_add_u32 v9, v9, 4, v10
    v_subrev_u32 v9, 1024, v9
    v_add_u32 v3, s60, v9
    v_add_u32 v9, 128, v1
    v_mul_u32_u24 v10, 6554, v9
    v_lshrrev_b32 v10, 16, v10
    v_mul_u32_u24 v11, 10, v10
    v_sub_u32 v9, v9, v11
    v_mul_u32_u24 v10, 1280, v10
    v_lshl_add_u32 v9, v9, 4, v10
    v_subrev_u32 v9, 2048, v9
    v_add_u32 v4, s60, v9
    v_add_u32 v9, 192, v1
    v_mul_u32_u24 v10, 6554, v9
    v_lshrrev_b32 v10, 16, v10
    v_mul_u32_u24 v11, 10, v10
    v_sub_u32 v9, v9, v11
    v_mul_u32_u24 v10, 1280, v10
    v_lshl_add_u32 v9, v9, 4, v10
    v_subrev_u32 v9, 3072, v9
    v_add_u32 v6, s60, v9
    v_add_u32 v9, 256, v1
    v_mul_u32_u24 v10, 6554, v9
    v_lshrrev_b32 v10, 16, v10
    v_mul_u32_u24 v11, 10, v10
    v_sub_u32 v9, v9, v11
    v_mul_u32_u24 v10, 1280, v10
    v_lshl_add_u32 v9, v9, 4, v10
    v_add_u32 v7, s60, v9
    v_mov_b32 v9, 98304
    v_mov_b32 v10, 0
    ds_write_b32 v9, v10
    s_waitcnt lgkmcnt(0)
    s_waitcnt vmcnt(6)
    s_barrier
    s_lshr_b32 s69, s23, 5
    s_lshl_b32 s69, s69, 12
    s_add_u32 s69, s69, 14188544
    v_lshlrev_b32 v12, 4, v1
    s_mov_b32 s44, 400000
Lpoll_28:
    buffer_load_dwordx4 v[14:17], v12, s[32:35], s69 offen sc1
Lpck_30:
    s_waitcnt vmcnt(0)
    v_xor_b32 v14, s66, v14
    v_xor_b32 v15, s66, v15
    v_xor_b32 v16, s66, v16
    v_xor_b32 v17, s66, v17
    v_or_b32 v14, v14, v15
    v_or_b32 v14, v14, v16
    v_or_b32 v14, v14, v17
    v_cmp_ne_u32 vcc, 0, v14
    s_nop 1
    s_cmp_lg_u64 vcc, 0
    s_cbranch_scc0 Lpok_29
    s_sub_u32 s44, s44, 1
    s_cbranch_scc0 Lpoll_28
Lpok_29:
    s_lshl_b32 s60, s55, 4
    s_mul_i32 s61, s47, 671744
    s_add_u32 s60, s60, s61
    s_add_u32 s60, s60, 5242880
    s_lshl_b32 s61, s47, 12
    s_add_u32 s61, s61, 57344
    v_lshrrev_b32 v12, 1, v1
    v_and_b32 v13, 1, v1
    v_mul_u32_u24 v12, 5248, v12
    v_lshl_add_u32 v12, v13, 4, v12
    s_cmp_eq_u32 s56, 0
    s_cselect_b32 exec_lo, 0x55555555, -1
    s_cselect_b32 exec_hi, 0x55555555, -1
    s_add_u32 s68, s64, 0
    s_and_b32 s68, s68, 3
    s_lshl_b32 s69, s68, 10
    s_add_u32 m0, s61, s69
    s_mul_i32 s68, s68, 167936
    s_add_u32 s68, s68, s60
    buffer_load_dwordx4 v12, s[32:35], s68 offen sc1 lds
    s_add_u32 s68, s64, 1
    s_and_b32 s68, s68, 3
    s_lshl_b32 s69, s68, 10
    s_add_u32 m0, s61, s69
    s_mul_i32 s68, s68, 167936
    s_add_u32 s68, s68, s60
    buffer_load_dwordx4 v12, s[32:35], s68 offen sc1 lds
    s_add_u32 s68, s64, 2
    s_and_b32 s68, s68, 3
    s_lshl_b32 s69, s68, 10
    s_add_u32 m0, s61, s69
    s_mul_i32 s68, s68, 167936
    s_add_u32 s68, s68, s60
    buffer_load_dwordx4 v12, s[32:35], s68 offen sc1 lds
    s_add_u32 s68, s64, 3
    s_and_b32 s68, s68, 3
    s_lshl_b32 s69, s68, 10
    s_add_u32 m0, s61, s69
    s_mul_i32 s68, s68, 167936
    s_add_u32 s68, s68, s60
    buffer_load_dwordx4 v12, s[32:35], s68 offen sc1 lds
    s_mov_b64 exec, -1
    s_add_u32 m0, s46, s54
    s_add_u32 s60, s48, 4096
    buffer_load_dwordx4 v5, s[32:35], s48 offen offset:0 sc1 lds
    buffer_load_dwordx4 v5, s[32:35], s48 offen offset:1024 sc1 lds
    buffer_load_dwordx4 v5, s[32:35], s48 offen offset:2048 sc1 lds
    buffer_load_dwordx4 v5, s[32:35], s48 offen offset:3072 sc1 lds
    s_add_u32 m0, m0, 4096
    s_add_u32 s48, s48, 21504
    buffer_load_dwordx4 v5, s[32:35], s60 offen offset:0 sc1 lds
    buffer_load_dwordx4 v5, s[32:35], s60 offen offset:1024 sc1 lds
    s_add_u32 s46, s46, 21504
    s_cmp_ge_u32 s46, 163840
    s_cselect_b32 s46, 99328, s46
    s_waitcnt vmcnt(6)
    s_barrier
    s_add_u32 m0, s46, s54
    s_add_u32 s60, s48, 4096
    buffer_load_dwordx4 v5, s[32:35], s48 offen offset:0 sc1 lds
    buffer_load_dwordx4 v5, s[32:35], s48 offen offset:1024 sc1 lds
    buffer_load_dwordx4 v5, s[32:35], s48 offen offset:2048 sc1 lds
    buffer_load_dwordx4 v5, s[32:35], s48 offen offset:3072 sc1 lds
    s_add_u32 m0, m0, 4096
    s_add_u32 s48, s48, 21504
    buffer_load_dwordx4 v5, s[32:35], s60 offen offset:0 sc1 lds
    buffer_load_dwordx4 v5, s[32:35], s60 offen offset:1024 sc1 lds
    s_add_u32 s46, s46, 21504
    s_cmp_ge_u32 s46, 163840
    s_cselect_b32 s46, 99328, s46
    s_cmp_gt_u32 s57, 320
    s_cbranch_scc1 Lnocol_31
    s_lshl_b32 s60, s57, 4
    s_mul_i32 s61, s58, 167936
    s_add_u32 s60, s60, s61
    s_add_u32 s60, s60, 7995392
    v_and_b32 v9, 32, v1
    v_add_u32 v9, v9, v1
    v_mul_u32_u24 v9, 5248, v9
    buffer_load_dwordx4 v[44:47], v9, s[32:35], s60 offen sc1
    s_add_u32 s60, s60, 671744
    buffer_load_dwordx4 v[48:51], v9, s[32:35], s60 offen sc1
    s_add_u32 s60, s60, 671744
    buffer_load_dwordx4 v[52:55], v9, s[32:35], s60 offen sc1
    s_add_u32 s60, s60, 671744
    buffer_load_dwordx4 v[56:59], v9, s[32:35], s60 offen sc1
    s_add_u32 s60, s60, 671744
    s_lshl_b32 s60, s59, 4
    s_add_u32 s60, s60, 57344
    v_lshl_add_u32 v9, v1, 5, s60
    s_lshl_b32 s61, s58, 14
    s_add_u32 s61, s61, 0
    v_add_u32 v10, s61, v5
    ds_read_b128 v[92:95], v9 offset:0
    ds_read_b128 v[96:99], v10 offset:0
    ds_read_b128 v[100:103], v10 offset:8192
    s_waitcnt lgkmcnt(0)
    v_mfma_f32_32x32x16_bf16 v[12:27], v[92:95], v[96:99], 0
    v_mfma_f32_32x32x16_bf16 v[28:43], v[92:95], v[100:103], 0
    ds_read_b128 v[104:107], v9 offset:2048
    ds_read_b128 v[108:111], v10 offset:1024
    ds_read_b128 v[112:115], v10 offset:9216
    s_waitcnt lgkmcnt(0)
    v_mfma_f32_32x32x16_bf16 v[12:27], v[104:107], v[108:111], v[12:27]
    v_mfma_f32_32x32x16_bf16 v[28:43], v[104:107], v[112:115], v[28:43]
    ds_read_b128 v[92:95], v9 offset:4096
    ds_read_b128 v[96:99], v10 offset:2048
    ds_read_b128 v[100:103], v10 offset:10240
    s_waitcnt lgkmcnt(0)
    v_mfma_f32_32x32x16_bf16 v[12:27], v[92:95], v[96:99], v[12:27]
    v_mfma_f32_32x32x16_bf16 v[28:43], v[92:95], v[100:103], v[28:43]
    ds_read_b128 v[104:107], v9 offset:6144
    ds_read_b128 v[108:111], v10 offset:3072
    ds_read_b128 v[112:115], v10 offset:11264
    s_waitcnt lgkmcnt(0)
    v_mfma_f32_32x32x16_bf16 v[12:27], v[104:107], v[108:111], v[12:27]
    v_mfma_f32_32x32x16_bf16 v[28:43], v[104:107], v[112:115], v[28:43]
    ds_read_b128 v[92:95], v9 offset:8192
    ds_read_b128 v[96:99], v10 offset:4096
    ds_read_b128 v[100:103], v10 offset:12288
    s_waitcnt lgkmcnt(0)
    v_mfma_f32_32x32x16_bf16 v[12:27], v[92:95], v[96:99], v[12:27]
    v_mfma_f32_32x32x16_bf16 v[28:43], v[92:95], v[100:103], v[28:43]
    ds_read_b128 v[104:107], v9 offset:10240
    ds_read_b128 v[108:111], v10 offset:5120
    ds_read_b128 v[112:115], v10 offset:13312
    s_waitcnt lgkmcnt(0)
    v_mfma_f32_32x32x16_bf16 v[12:27], v[104:107], v[108:111], v[12:27]
    v_mfma_f32_32x32x16_bf16 v[28:43], v[104:107], v[112:115], v[28:43]
    ds_read_b128 v[92:95], v9 offset:12288
    ds_read_b128 v[96:99], v10 offset:6144
    ds_read_b128 v[100:103], v10 offset:14336
    s_waitcnt lgkmcnt(0)
    v_mfma_f32_32x32x16_bf16 v[12:27], v[92:95], v[96:99], v[12:27]
    v_mfma_f32_32x32x16_bf16 v[28:43], v[92:95], v[100:103], v[28:43]
    ds_read_b128 v[104:107], v9 offset:14336
    ds_read_b128 v[108:111], v10 offset:7168
    ds_read_b128 v[112:115], v10 offset:15360
    s_waitcnt lgkmcnt(0)
    v_mfma_f32_32x32x16_bf16 v[12:27], v[104:107], v[108:111], v[12:27]
    v_mfma_f32_32x32x16_bf16 v[28:43], v[104:107], v[112:115], v[28:43]
    s_lshl_b32 s61, s58, 13
    s_add_u32 s61, s61, 40960
    v_add_u32 v9, s61, v5
    v_add_u32 v10, 32768, v5
    ds_read_b128 v[60:63], v9 offset:0
    ds_read_b128 v[76:79], v9 offset:4096
    ds_read_b128 v[64:67], v9 offset:1024
    ds_read_b128 v[80:83], v9 offset:5120
    ds_read_b128 v[68:71], v9 offset:2048
    ds_read_b128 v[84:87], v9 offset:6144
    ds_read_b128 v[72:75], v9 offset:3072
    ds_read_b128 v[88:91], v9 offset:7168
    s_waitcnt lgkmcnt(0)
    ds_read_b128 v[92:95], v10 offset:0
    ds_read_b128 v[96:99], v10 offset:1024
    ds_read_b128 v[100:103], v10 offset:2048
    ds_read_b128 v[104:107], v10 offset:3072
    ds_read_b128 v[108:111], v10 offset:4096
    ds_read_b128 v[112:115], v10 offset:5120
    ds_read_b128 v[116:119], v10 offset:6144
    ds_read_b128 v[120:123], v10 offset:7168
    v_pk_mul_f32 v[140:141], v[12:13], v[60:61]
    v_pk_mul_f32 v[142:143], v[28:29], v[60:61]
    v_pk_fma_f32 v[140:141], v[28:29], v[76:77], v[140:141]
    v_pk_fma_f32 v[142:143], v[12:13], v[76:77], v[142:143] neg_lo:[0,1,0] neg_hi:[0,1,0]
    v_cvt_pk_bf16_f32 v124, v140, v142
    v_cvt_pk_bf16_f32 v125, v141, v143
    v_pk_mul_f32 v[144:145], v[14:15], v[62:63]
    v_pk_mul_f32 v[146:147], v[30:31], v[62:63]
    v_pk_fma_f32 v[144:145], v[30:31], v[78:79], v[144:145]
    v_pk_fma_f32 v[146:147], v[14:15], v[78:79], v[146:147] neg_lo:[0,1,0] neg_hi:[0,1,0]
    v_cvt_pk_bf16_f32 v126, v144, v146
    v_cvt_pk_bf16_f32 v127, v145, v147
    v_pk_mul_f32 v[140:141], v[16:17], v[64:65]
    v_pk_mul_f32 v[142:143], v[32:33], v[64:65]
    v_pk_fma_f32 v[140:141], v[32:33], v[80:81], v[140:141]
    v_pk_fma_f32 v[142:143], v[16:17], v[80:81], v[142:143] neg_lo:[0,1,0] neg_hi:[0,1,0]
    v_cvt_pk_bf16_f32 v128, v140, v142
    v_cvt_pk_bf16_f32 v129, v141, v143
    v_pk_mul_f32 v[144:145], v[18:19], v[66:67]
    v_pk_mul_f32 v[146:147], v[34:35], v[66:67]
    v_pk_fma_f32 v[144:145], v[34:35], v[82:83], v[144:145]
    v_pk_fma_f32 v[146:147], v[18:19], v[82:83], v[146:147] neg_lo:[0,1,0] neg_hi:[0,1,0]
    v_cvt_pk_bf16_f32 v130, v144, v146
    v_cvt_pk_bf16_f32 v131, v145, v147
    v_pk_mul_f32 v[140:141], v[20:21], v[68:69]
    v_pk_mul_f32 v[142:143], v[36:37], v[68:69]
    v_pk_fma_f32 v[140:141], v[36:37], v[84:85], v[140:141]
    v_pk_fma_f32 v[142:143], v[20:21], v[84:85], v[142:143] neg_lo:[0,1,0] neg_hi:[0,1,0]
    v_cvt_pk_bf16_f32 v132, v140, v142
    v_cvt_pk_bf16_f32 v133, v141, v143
    v_pk_mul_f32 v[144:145], v[22:23], v[70:71]
    v_pk_mul_f32 v[146:147], v[38:39], v[70:71]
    v_pk_fma_f32 v[144:145], v[38:39], v[86:87], v[144:145]
    v_pk_fma_f32 v[146:147], v[22:23], v[86:87], v[146:147] neg_lo:[0,1,0] neg_hi:[0,1,0]
    v_cvt_pk_bf16_f32 v134, v144, v146
    v_cvt_pk_bf16_f32 v135, v145, v147
    v_pk_mul_f32 v[140:141], v[24:25], v[72:73]
    v_pk_mul_f32 v[142:143], v[40:41], v[72:73]
    v_pk_fma_f32 v[140:141], v[40:41], v[88:89], v[140:141]
    v_pk_fma_f32 v[142:143], v[24:25], v[88:89], v[142:143] neg_lo:[0,1,0] neg_hi:[0,1,0]
    v_cvt_pk_bf16_f32 v136, v140, v142
    v_cvt_pk_bf16_f32 v137, v141, v143
    v_pk_mul_f32 v[144:145], v[26:27], v[74:75]
    v_pk_mul_f32 v[146:147], v[42:43], v[74:75]
    v_pk_fma_f32 v[144:145], v[42:43], v[90:91], v[144:145]
    v_pk_fma_f32 v[146:147], v[26:27], v[90:91], v[146:147] neg_lo:[0,1,0] neg_hi:[0,1,0]
    v_cvt_pk_bf16_f32 v138, v144, v146
    v_cvt_pk_bf16_f32 v139, v145, v147
Lnocol_31:
    s_waitcnt vmcnt(0)
    s_barrier
    s_add_u32 m0, s46, s54
    s_add_u32 s60, s48, 4096
    buffer_load_dwordx4 v5, s[32:35], s48 offen offset:0 sc1 lds
    buffer_load_dwordx4 v5, s[32:35], s48 offen offset:1024 sc1 lds
    buffer_load_dwordx4 v5, s[32:35], s48 offen offset:2048 sc1 lds
    buffer_load_dwordx4 v5, s[32:35], s48 offen offset:3072 sc1 lds
    s_add_u32 m0, m0, 4096
    s_add_u32 s48, s48, 21504
    buffer_load_dwordx4 v5, s[32:35], s60 offen offset:0 sc1 lds
    buffer_load_dwordx4 v5, s[32:35], s60 offen offset:1024 sc1 lds
    s_add_u32 s46, s46, 21504
    s_cmp_ge_u32 s46, 163840
    s_cselect_b32 s46, 99328, s46
    s_cmp_gt_u32 s57, 320
    s_cbranch_scc1 Lnocol_32
    s_cmp_eq_u32 s57, 0
    s_cselect_b32 s60, 0x3f000000, 1.0
    s_cmp_eq_u32 s57, 320
    s_cselect_b32 s60, 0x3f000000, s60
    s_waitcnt lgkmcnt(0)
    v_mfma_f32_32x32x16_bf16 v[12:27], v[92:95], v[124:127], 0
    v_lshlrev_b32 v148, 16, v44
    v_and_b32 v156, 0xffff0000, v44
    v_mfma_f32_32x32x16_bf16 v[28:43], v[108:111], v[124:127], 0
    v_lshlrev_b32 v149, 16, v45
    v_and_b32 v157, 0xffff0000, v45
    v_mfma_f32_32x32x16_bf16 v[12:27], v[96:99], v[128:131], v[12:27]
    v_lshlrev_b32 v150, 16, v46
    v_and_b32 v158, 0xffff0000, v46
    v_mfma_f32_32x32x16_bf16 v[28:43], v[112:115], v[128:131], v[28:43]
    v_lshlrev_b32 v151, 16, v47
    v_and_b32 v159, 0xffff0000, v47
    v_mfma_f32_32x32x16_bf16 v[12:27], v[100:103], v[132:135], v[12:27]
    v_lshlrev_b32 v152, 16, v48
    v_and_b32 v160, 0xffff0000, v48
    v_mfma_f32_32x32x16_bf16 v[28:43], v[116:119], v[132:135], v[28:43]
    v_lshlrev_b32 v153, 16, v49
    v_and_b32 v161, 0xffff0000, v49
    v_mfma_f32_32x32x16_bf16 v[12:27], v[104:107], v[136:139], v[12:27]
    v_lshlrev_b32 v154, 16, v50
    v_and_b32 v162, 0xffff0000, v50
    v_mfma_f32_32x32x16_bf16 v[28:43], v[120:123], v[136:139], v[28:43]
    v_lshlrev_b32 v155, 16, v51
    v_and_b32 v163, 0xffff0000, v51
    s_nop 7
    s_cmp_eq_u32 s60, 1.0
    s_cbranch_scc1 Lnoscale_33
    v_mul_f32 v148, s60, v148
    v_mul_f32 v149, s60, v149
    v_mul_f32 v150, s60, v150
    v_mul_f32 v151, s60, v151
    v_mul_f32 v152, s60, v152
    v_mul_f32 v153, s60, v153
    v_mul_f32 v154, s60, v154
    v_mul_f32 v155, s60, v155
    v_mul_f32 v156, s60, v156
    v_mul_f32 v157, s60, v157
    v_mul_f32 v158, s60, v158
    v_mul_f32 v159, s60, v159
    v_mul_f32 v160, s60, v160
    v_mul_f32 v161, s60, v161
    v_mul_f32 v162, s60, v162
    v_mul_f32 v163, s60, v163
Lnoscale_33:
    v_pk_mul_f32 v[140:141], v[12:13], v[148:149]
    v_pk_mul_f32 v[142:143], v[28:29], v[148:149]
    v_pk_fma_f32 v[140:141], v[28:29], v[156:157], v[140:141] neg_lo:[0,1,0] neg_hi:[0,1,0]
    v_pk_fma_f32 v[142:143], v[12:13], v[156:157], v[142:143]
    v_cvt_pk_bf16_f32 v124, v140, -v142
    v_cvt_pk_bf16_f32 v125, v141, -v143
    v_pk_mul_f32 v[144:145], v[14:15], v[150:151]
    v_pk_mul_f32 v[146:147], v[30:31], v[150:151]
    v_pk_fma_f32 v[144:145], v[30:31], v[158:159], v[144:145] neg_lo:[0,1,0] neg_hi:[0,1,0]
    v_pk_fma_f32 v[146:147], v[14:15], v[158:159], v[146:147]
    v_cvt_pk_bf16_f32 v126, v144, -v146
    v_cvt_pk_bf16_f32 v127, v145, -v147
    v_pk_mul_f32 v[140:141], v[16:17], v[152:153]
    v_pk_mul_f32 v[142:143], v[32:33], v[152:153]
    v_pk_fma_f32 v[140:141], v[32:33], v[160:161], v[140:141] neg_lo:[0,1,0] neg_hi:[0,1,0]
    v_pk_fma_f32 v[142:143], v[16:17], v[160:161], v[142:143]
    v_cvt_pk_bf16_f32 v128, v140, -v142
    v_cvt_pk_bf16_f32 v129, v141, -v143
    v_pk_mul_f32 v[144:145], v[18:19], v[154:155]
    v_pk_mul_f32 v[146:147], v[34:35], v[154:155]
    v_pk_fma_f32 v[144:145], v[34:35], v[162:163], v[144:145] neg_lo:[0,1,0] neg_hi:[0,1,0]
    v_pk_fma_f32 v[146:147], v[18:19], v[162:163], v[146:147]
    v_cvt_pk_bf16_f32 v130, v144, -v146
    v_cvt_pk_bf16_f32 v131, v145, -v147
    v_lshlrev_b32 v148, 16, v52
    v_and_b32 v156, 0xffff0000, v52
    v_lshlrev_b32 v149, 16, v53
    v_and_b32 v157, 0xffff0000, v53
    v_lshlrev_b32 v150, 16, v54
    v_and_b32 v158, 0xffff0000, v54
    v_lshlrev_b32 v151, 16, v55
    v_and_b32 v159, 0xffff0000, v55
    v_lshlrev_b32 v152, 16, v56
    v_and_b32 v160, 0xffff0000, v56
    v_lshlrev_b32 v153, 16, v57
    v_and_b32 v161, 0xffff0000, v57
    v_lshlrev_b32 v154, 16, v58
    v_and_b32 v162, 0xffff0000, v58
    v_lshlrev_b32 v155, 16, v59
    v_and_b32 v163, 0xffff0000, v59
    s_cmp_eq_u32 s60, 1.0
    s_cbranch_scc1 Lnoscale_34
    v_mul_f32 v148, s60, v148
    v_mul_f32 v149, s60, v149
    v_mul_f32 v150, s60, v150
    v_mul_f32 v151, s60, v151
    v_mul_f32 v152, s60, v152
    v_mul_f32 v153, s60, v153
    v_mul_f32 v154, s60, v154
    v_mul_f32 v155, s60, v155
    v_mul_f32 v156, s60, v156
    v_mul_f32 v157, s60, v157
    v_mul_f32 v158, s60, v158
    v_mul_f32 v159, s60, v159
    v_mul_f32 v160, s60, v160
    v_mul_f32 v161, s60, v161
    v_mul_f32 v162, s60, v162
    v_mul_f32 v163, s60, v163
Lnoscale_34:
    v_pk_mul_f32 v[140:141], v[20:21], v[148:149]
    v_pk_mul_f32 v[142:143], v[36:37], v[148:149]
    v_pk_fma_f32 v[140:141], v[36:37], v[156:157], v[140:141] neg_lo:[0,1,0] neg_hi:[0,1,0]
    v_pk_fma_f32 v[142:143], v[20:21], v[156:157], v[142:143]
    v_cvt_pk_bf16_f32 v132, v140, -v142
    v_cvt_pk_bf16_f32 v133, v141, -v143
    v_pk_mul_f32 v[144:145], v[22:23], v[150:151]
    v_pk_mul_f32 v[146:147], v[38:39], v[150:151]
    v_pk_fma_f32 v[144:145], v[38:39], v[158:159], v[144:145] neg_lo:[0,1,0] neg_hi:[0,1,0]
    v_pk_fma_f32 v[146:147], v[22:23], v[158:159], v[146:147]
    v_cvt_pk_bf16_f32 v134, v144, -v146
    v_cvt_pk_bf16_f32 v135, v145, -v147
    v_pk_mul_f32 v[140:141], v[24:25], v[152:153]
    v_pk_mul_f32 v[142:143], v[40:41], v[152:153]
    v_pk_fma_f32 v[140:141], v[40:41], v[160:161], v[140:141] neg_lo:[0,1,0] neg_hi:[0,1,0]
    v_pk_fma_f32 v[142:143], v[24:25], v[160:161], v[142:143]
    v_cvt_pk_bf16_f32 v136, v140, -v142
    v_cvt_pk_bf16_f32 v137, v141, -v143
    v_pk_mul_f32 v[144:145], v[26:27], v[154:155]
    v_pk_mul_f32 v[146:147], v[42:43], v[154:155]
    v_pk_fma_f32 v[144:145], v[42:43], v[162:163], v[144:145] neg_lo:[0,1,0] neg_hi:[0,1,0]
    v_pk_fma_f32 v[146:147], v[26:27], v[162:163], v[146:147]
    v_cvt_pk_bf16_f32 v138, v144, -v146
    v_cvt_pk_bf16_f32 v139, v145, -v147
    s_nop 1
    v_mfma_f32_32x32x16_bf16 v[12:27], v[92:95], v[124:127], 0
    v_mfma_f32_32x32x16_bf16 v[28:43], v[108:111], v[124:127], 0
    v_mfma_f32_32x32x16_bf16 v[12:27], v[96:99], v[128:131], v[12:27]
    v_mfma_f32_32x32x16_bf16 v[28:43], v[112:115], v[128:131], v[28:43]
    v_mfma_f32_32x32x16_bf16 v[12:27], v[100:103], v[132:135], v[12:27]
    v_mfma_f32_32x32x16_bf16 v[28:43], v[116:119], v[132:135], v[28:43]
    v_mfma_f32_32x32x16_bf16 v[12:27], v[104:107], v[136:139], v[12:27]
    v_mfma_f32_32x32x16_bf16 v[28:43], v[120:123], v[136:139], v[28:43]
    s_mul_i32 s60, s59, 8704
    s_lshl_b32 s61, s58, 7
    s_add_u32 s60, s60, s61
    s_add_u32 s60, s60, 73728
    v_lshrrev_b32 v9, 5, v1
    v_mul_u32_u24 v9, 1088, v9
    v_and_b32 v10, 31, v1
    v_lshl_add_u32 v9, v10, 2, v9
    v_add_u32 v9, s60, v9
    s_nop 2
    v_pk_mul_f32 v[140:141], v[12:13], v[60:61]
    v_pk_mul_f32 v[142:143], v[28:29], v[60:61]
    v_pk_fma_f32 v[140:141], v[28:29], v[76:77], v[140:141]
    v_pk_fma_f32 v[142:143], v[12:13], v[76:77], v[142:143] neg_lo:[0,1,0] neg_hi:[0,1,0]
    v_cvt_pk_bf16_f32 v124, v140, v142
    v_cvt_pk_bf16_f32 v125, v141, v143
    v_pk_mul_f32 v[144:145], v[14:15], v[62:63]
    v_pk_mul_f32 v[146:147], v[30:31], v[62:63]
    v_pk_fma_f32 v[144:145], v[30:31], v[78:79], v[144:145]
    v_pk_fma_f32 v[146:147], v[14:15], v[78:79], v[146:147] neg_lo:[0,1,0] neg_hi:[0,1,0]
    v_cvt_pk_bf16_f32 v126, v144, v146
    v_cvt_pk_bf16_f32 v127, v145, v147
    v_pk_mul_f32 v[140:141], v[16:17], v[64:65]
    v_pk_mul_f32 v[142:143], v[32:33], v[64:65]
    v_pk_fma_f32 v[140:141], v[32:33], v[80:81], v[140:141]
    v_pk_fma_f32 v[142:143], v[16:17], v[80:81], v[142:143] neg_lo:[0,1,0] neg_hi:[0,1,0]
    v_cvt_pk_bf16_f32 v128, v140, v142
    v_cvt_pk_bf16_f32 v129, v141, v143
    v_pk_mul_f32 v[144:145], v[18:19], v[66:67]
    v_pk_mul_f32 v[146:147], v[34:35], v[66:67]
    v_pk_fma_f32 v[144:145], v[34:35], v[82:83], v[144:145]
    v_pk_fma_f32 v[146:147], v[18:19], v[82:83], v[146:147] neg_lo:[0,1,0] neg_hi:[0,1,0]
    v_cvt_pk_bf16_f32 v130, v144, v146
    v_cvt_pk_bf16_f32 v131, v145, v147
    v_pk_mul_f32 v[140:141], v[20:21], v[68:69]
    v_pk_mul_f32 v[142:143], v[36:37], v[68:69]
    v_pk_fma_f32 v[140:141], v[36:37], v[84:85], v[140:141]
    v_pk_fma_f32 v[142:143], v[20:21], v[84:85], v[142:143] neg_lo:[0,1,0] neg_hi:[0,1,0]
    v_cvt_pk_bf16_f32 v132, v140, v142
    v_cvt_pk_bf16_f32 v133, v141, v143
    v_pk_mul_f32 v[144:145], v[22:23], v[70:71]
    v_pk_mul_f32 v[146:147], v[38:39], v[70:71]
    v_pk_fma_f32 v[144:145], v[38:39], v[86:87], v[144:145]
    v_pk_fma_f32 v[146:147], v[22:23], v[86:87], v[146:147] neg_lo:[0,1,0] neg_hi:[0,1,0]
    v_cvt_pk_bf16_f32 v134, v144, v146
    v_cvt_pk_bf16_f32 v135, v145, v147
    v_pk_mul_f32 v[140:141], v[24:25], v[72:73]
    v_pk_mul_f32 v[142:143], v[40:41], v[72:73]
    v_pk_fma_f32 v[140:141], v[40:41], v[88:89], v[140:141]
    v_pk_fma_f32 v[142:143], v[24:25], v[88:89], v[142:143] neg_lo:[0,1,0] neg_hi:[0,1,0]
    v_cvt_pk_bf16_f32 v136, v140, v142
    v_cvt_pk_bf16_f32 v137, v141, v143
    v_pk_mul_f32 v[144:145], v[26:27], v[74:75]
    v_pk_mul_f32 v[146:147], v[42:43], v[74:75]
    v_pk_fma_f32 v[144:145], v[42:43], v[90:91], v[144:145]
    v_pk_fma_f32 v[146:147], v[26:27], v[90:91], v[146:147] neg_lo:[0,1,0] neg_hi:[0,1,0]
    v_cvt_pk_bf16_f32 v138, v144, v146
    v_cvt_pk_bf16_f32 v139, v145, v147
    ds_write_b32 v9, v124 offset:0
    ds_write_b32 v9, v125 offset:272
    ds_write_b32 v9, v126 offset:544
    ds_write_b32 v9, v127 offset:816
    ds_write_b32 v9, v128 offset:2176
    ds_write_b32 v9, v129 offset:2448
    ds_write_b32 v9, v130 offset:2720
    ds_write_b32 v9, v131 offset:2992
    ds_write_b32 v9, v132 offset:4352
    ds_write_b32 v9, v133 offset:4624
    ds_write_b32 v9, v134 offset:4896
    ds_write_b32 v9, v135 offset:5168
    ds_write_b32 v9, v136 offset:6528
    ds_write_b32 v9, v137 offset:6800
    ds_write_b32 v9, v138 offset:7072
    ds_write_b32 v9, v139 offset:7344
    s_waitcnt lgkmcnt(0)
Lnocol_32:
    s_waitcnt vmcnt(6)
    s_barrier
    s_add_u32 m0, s46, s54
    s_add_u32 s60, s48, 4096
    buffer_load_dwordx4 v5, s[32:35], s48 offen offset:0 sc1 lds
    buffer_load_dwordx4 v5, s[32:35], s48 offen offset:1024 sc1 lds
    buffer_load_dwordx4 v5, s[32:35], s48 offen offset:2048 sc1 lds
    buffer_load_dwordx4 v5, s[32:35], s48 offen offset:3072 sc1 lds
    s_add_u32 m0, m0, 4096
    s_add_u32 s48, s48, 21504
    buffer_load_dwordx4 v5, s[32:35], s60 offen offset:0 sc1 lds
    buffer_load_dwordx4 v5, s[32:35], s60 offen offset:1024 sc1 lds
    s_add_u32 s46, s46, 21504
    s_cmp_ge_u32 s46, 163840
    s_cselect_b32 s46, 99328, s46
    s_cmp_gt_u32 s57, 320
    s_cbranch_scc1 Lnocol_35
    s_mul_i32 s60, s59, 8704
    s_add_u32 s60, s60, 73728
    v_and_b32 v9, 31, v1
    v_mul_u32_u24 v9, 272, v9
    v_lshrrev_b32 v10, 5, v1
    v_lshl_add_u32 v9, v10, 4, v9
    v_add_u32 v9, s60, v9
    s_lshl_b32 s61, s58, 14
    s_add_u32 s61, s61, 0
    v_add_u32 v10, s61, v5
    ds_read_b128 v[92:95], v9 offset:0
    ds_read_b128 v[96:99], v10 offset:0
    ds_read_b128 v[100:103], v10 offset:8192
    s_waitcnt lgkmcnt(0)
    v_mfma_f32_32x32x16_bf16 v[12:27], v[96:99], v[92:95], 0
    v_mfma_f32_32x32x16_bf16 v[28:43], v[100:103], v[92:95], 0
    ds_read_b128 v[104:107], v9 offset:32
    ds_read_b128 v[108:111], v10 offset:1024
    ds_read_b128 v[112:115], v10 offset:9216
    s_waitcnt lgkmcnt(0)
    v_mfma_f32_32x32x16_bf16 v[12:27], v[108:111], v[104:107], v[12:27]
    v_mfma_f32_32x32x16_bf16 v[28:43], v[112:115], v[104:107], v[28:43]
    ds_read_b128 v[92:95], v9 offset:64
    ds_read_b128 v[96:99], v10 offset:2048
    ds_read_b128 v[100:103], v10 offset:10240
    s_waitcnt lgkmcnt(0)
    v_mfma_f32_32x32x16_bf16 v[12:27], v[96:99], v[92:95], v[12:27]
    v_mfma_f32_32x32x16_bf16 v[28:43], v[100:103], v[92:95], v[28:43]
    ds_read_b128 v[104:107], v9 offset:96
    ds_read_b128 v[108:111], v10 offset:3072
    ds_read_b128 v[112:115], v10 offset:11264
    s_waitcnt lgkmcnt(0)
    v_mfma_f32_32x32x16_bf16 v[12:27], v[108:111], v[104:107], v[12:27]
    v_mfma_f32_32x32x16_bf16 v[28:43], v[112:115], v[104:107], v[28:43]
    ds_read_b128 v[92:95], v9 offset:128
    ds_read_b128 v[96:99], v10 offset:4096
    ds_read_b128 v[100:103], v10 offset:12288
    s_waitcnt lgkmcnt(0)
    v_mfma_f32_32x32x16_bf16 v[12:27], v[96:99], v[92:95], v[12:27]
    v_mfma_f32_32x32x16_bf16 v[28:43], v[100:103], v[92:95], v[28:43]
    ds_read_b128 v[104:107], v9 offset:160
    ds_read_b128 v[108:111], v10 offset:5120
    ds_read_b128 v[112:115], v10 offset:13312
    s_waitcnt lgkmcnt(0)
    v_mfma_f32_32x32x16_bf16 v[12:27], v[108:111], v[104:107], v[12:27]
    v_mfma_f32_32x32x16_bf16 v[28:43], v[112:115], v[104:107], v[28:43]
    ds_read_b128 v[92:95], v9 offset:192
    ds_read_b128 v[96:99], v10 offset:6144
    ds_read_b128 v[100:103], v10 offset:14336
    s_waitcnt lgkmcnt(0)
    v_mfma_f32_32x32x16_bf16 v[12:27], v[96:99], v[92:95], v[12:27]
    v_mfma_f32_32x32x16_bf16 v[28:43], v[100:103], v[92:95], v[28:43]
    ds_read_b128 v[104:107], v9 offset:224
    ds_read_b128 v[108:111], v10 offset:7168
    ds_read_b128 v[112:115], v10 offset:15360
    s_waitcnt lgkmcnt(0)
    v_mfma_f32_32x32x16_bf16 v[12:27], v[108:111], v[104:107], v[12:27]
    v_mfma_f32_32x32x16_bf16 v[28:43], v[112:115], v[104:107], v[28:43]
    s_mul_i32 s60, s57, 8320
    s_lshl_b32 s61, s58, 12
    s_add_u32 s60, s60, s61
    s_add_u32 s60, s60, 10747904
    s_nop 7
    v_cvt_pk_bf16_f32 v44, v12, -v28
    v_cvt_pk_bf16_f32 v45, v13, -v29
    v_cvt_pk_bf16_f32 v46, v14, -v30
    v_cvt_pk_bf16_f32 v47, v15, -v31
    buffer_store_dwordx4 v[44:47], v5, s[32:35], s60 offen offset:0 sc1
    v_cvt_pk_bf16_f32 v48, v16, -v32
    v_cvt_pk_bf16_f32 v49, v17, -v33
    v_cvt_pk_bf16_f32 v50, v18, -v34
    v_cvt_pk_bf16_f32 v51, v19, -v35
    buffer_store_dwordx4 v[48:51], v5, s[32:35], s60 offen offset:1024 sc1
    v_cvt_pk_bf16_f32 v52, v20, -v36
    v_cvt_pk_bf16_f32 v53, v21, -v37
    v_cvt_pk_bf16_f32 v54, v22, -v38
    v_cvt_pk_bf16_f32 v55, v23, -v39
    buffer_store_dwordx4 v[52:55], v5, s[32:35], s60 offen offset:2048 sc1
    v_cvt_pk_bf16_f32 v56, v24, -v40
    v_cvt_pk_bf16_f32 v57, v25, -v41
    v_cvt_pk_bf16_f32 v58, v26, -v42
    v_cvt_pk_bf16_f32 v59, v27, -v43
    buffer_store_dwordx4 v[56:59], v5, s[32:35], s60 offen offset:3072 sc1
Lnocol_35:
    s_cmp_le_u32 s57, 320
    s_cbranch_scc1 Lx_36
    s_waitcnt vmcnt(6)
Lx_36:
    s_waitcnt vmcnt(10)
    s_barrier
    s_add_u32 m0, s46, s54
    s_add_u32 s60, s48, 4096
    buffer_load_dwordx4 v5, s[32:35], s48 offen offset:0 sc1 lds
    buffer_load_dwordx4 v5, s[32:35], s48 offen offset:1024 sc1 lds
    buffer_load_dwordx4 v5, s[32:35], s48 offen offset:2048 sc1 lds
    buffer_load_dwordx4 v5, s[32:35], s48 offen offset:3072 sc1 lds
    s_add_u32 m0, m0, 4096
    s_add_u32 s48, s48, 21504
    buffer_load_dwordx4 v5, s[32:35], s60 offen offset:0 sc1 lds
    buffer_load_dwordx4 v5, s[32:35], s60 offen offset:1024 sc1 lds
    s_add_u32 s46, s46, 21504
    s_cmp_ge_u32 s46, 163840
    s_cselect_b32 s46, 99328, s46
    s_add_u32 s60, s47, 0
    s_min_u32 s60, s60, 19
    s_mul_i32 s61, s60, 5120
    s_mul_i32 s60, s60, 40960
    s_mov_b32 m0, s61
    s_nop 0
    buffer_load_dwordx4 v2, s[28:31], s60 offen offset:0 lds
    buffer_load_dwordx4 v3, s[28:31], s60 offen offset:1024 lds
    buffer_load_dwordx4 v4, s[28:31], s60 offen offset:2048 lds
    buffer_load_dwordx4 v6, s[28:31], s60 offen offset:3072 lds
    s_add_u32 m0, m0, 4096
    s_nop 0
    buffer_load_dwordx4 v7, s[28:31], s60 offen lds
    s_add_u32 s60, s47, 4
    s_min_u32 s60, s60, 19
    s_mul_i32 s61, s60, 5120
    s_mul_i32 s60, s60, 40960
    s_mov_b32 m0, s61
    s_nop 0
    buffer_load_dwordx4 v2, s[28:31], s60 offen offset:0 lds
    buffer_load_dwordx4 v3, s[28:31], s60 offen offset:1024 lds
    buffer_load_dwordx4 v4, s[28:31], s60 offen offset:2048 lds
    buffer_load_dwordx4 v6, s[28:31], s60 offen offset:3072 lds
    s_add_u32 m0, m0, 4096
    s_nop 0
    buffer_load_dwordx4 v7, s[28:31], s60 offen lds
    s_add_u32 s60, s47, 8
    s_min_u32 s60, s60, 19
    s_mul_i32 s61, s60, 5120
    s_mul_i32 s60, s60, 40960
    s_mov_b32 m0, s61
    s_nop 0
    buffer_load_dwordx4 v2, s[28:31], s60 offen offset:0 lds
    buffer_load_dwordx4 v3, s[28:31], s60 offen offset:1024 lds
    buffer_load_dwordx4 v4, s[28:31], s60 offen offset:2048 lds
    buffer_load_dwordx4 v6, s[28:31], s60 offen offset:3072 lds
    s_add_u32 m0, m0, 4096
    s_nop 0
    buffer_load_dwordx4 v7, s[28:31], s60 offen lds
    v_mov_b32 v9, 98304
    v_mov_b32 v10, 1
    s_mov_b64 exec, 1
    s_waitcnt vmcnt(21)
    ds_add_rtn_u32 v10, v9, v10
    s_waitcnt lgkmcnt(0)
    v_readfirstlane_b32 s60, v10
    s_mov_b64 exec, -1
    s_cmp_lg_u32 s60, 3
    s_cbranch_scc1 Lnz_37
    s_lshl_b32 s60, s23, 2
    s_add_u32 s60, s60, 14155776
    v_lshlrev_b32 v9, 12, v1
    v_mov_b32 v10, s66
    s_mov_b64 exec, 255
    buffer_store_dword v10, v9, s[32:35], s60 offen sc1
    s_mov_b64 exec, -1
Lnz_37:
    s_waitcnt vmcnt(21)
    s_barrier
    s_add_u32 s60, s47, 12
    s_min_u32 s60, s60, 19
    s_mul_i32 s61, s60, 5120
    s_mul_i32 s60, s60, 40960
    s_mov_b32 m0, s61
    s_nop 0
    buffer_load_dwordx4 v2, s[28:31], s60 offen offset:0 lds
    buffer_load_dwordx4 v3, s[28:31], s60 offen offset:1024 lds
    buffer_load_dwordx4 v4, s[28:31], s60 offen offset:2048 lds
    buffer_load_dwordx4 v6, s[28:31], s60 offen offset:3072 lds
    s_add_u32 m0, m0, 4096
    s_nop 0
    buffer_load_dwordx4 v7, s[28:31], s60 offen lds
    s_add_u32 s60, s47, 16
    s_min_u32 s60, s60, 19
    s_mul_i32 s61, s60, 5120
    s_mul_i32 s60, s60, 40960
    s_mov_b32 m0, s61
    s_nop 0
    buffer_load_dwordx4 v2, s[28:31], s60 offen offset:0 lds
    buffer_load_dwordx4 v3, s[28:31], s60 offen offset:1024 lds
    buffer_load_dwordx4 v4, s[28:31], s60 offen offset:2048 lds
    buffer_load_dwordx4 v6, s[28:31], s60 offen offset:3072 lds
    s_add_u32 m0, m0, 4096
    s_nop 0
    buffer_load_dwordx4 v7, s[28:31], s60 offen lds
    s_mov_b32 s60, 13819904
    buffer_load_dwordx4 v[48:51], v5, s[32:35], s60 offen offset:0 sc1
    buffer_load_dwordx4 v[52:55], v5, s[32:35], s60 offen offset:1024 sc1
    buffer_load_dwordx4 v[56:59], v5, s[32:35], s60 offen offset:2048 sc1
    buffer_load_dwordx4 v[60:63], v5, s[32:35], s60 offen offset:3072 sc1
    s_add_u32 s60, s60, 4096
    buffer_load_dwordx4 v[64:67], v5, s[32:35], s60 offen offset:0 sc1
    buffer_load_dwordx4 v[68:71], v5, s[32:35], s60 offen offset:1024 sc1
    buffer_load_dwordx4 v[72:75], v5, s[32:35], s60 offen offset:2048 sc1
    buffer_load_dwordx4 v[76:79], v5, s[32:35], s60 offen offset:3072 sc1
    s_add_u32 s60, s60, 4096
    buffer_load_dwordx4 v[36:39], v5, s[32:35], s60 offen sc1
    buffer_load_dwordx4 v[42:45], v5, s[32:35], s60 offen offset:1024 sc1
    buffer_load_dwordx2 v[40:41], v5, s[32:35], s60 offen offset:2048 sc1
    buffer_load_dwordx2 v[46:47], v5, s[32:35], s60 offen offset:3072 sc1
    s_mov_b32 s60, 13795328
    buffer_load_dwordx4 v[80:83], v5, s[32:35], s60 offen offset:0 sc1
    buffer_load_dwordx4 v[84:87], v5, s[32:35], s60 offen offset:1024 sc1
    buffer_load_dwordx4 v[88:91], v5, s[32:35], s60 offen offset:2048 sc1
    buffer_load_dwordx4 v[92:95], v5, s[32:35], s60 offen offset:3072 sc1
    s_lshr_b32 s69, s23, 5
    s_lshl_b32 s69, s69, 12
    s_add_u32 s69, s69, 14155776
    v_lshlrev_b32 v102, 4, v1
    s_waitcnt vmcnt(26)
    s_barrier
    s_mov_b32 s44, 400000
Lpoll_38:
    buffer_load_dwordx4 v[104:107], v102, s[32:35], s69 offen sc1
Lpck_40:
    s_waitcnt vmcnt(0)
    v_xor_b32 v104, s66, v104
    v_xor_b32 v105, s66, v105
    v_xor_b32 v106, s66, v106
    v_xor_b32 v107, s66, v107
    v_or_b32 v104, v104, v105
    v_or_b32 v104, v104, v106
    v_or_b32 v104, v104, v107
    v_cmp_ne_u32 vcc, 0, v104
    s_nop 1
    s_cmp_lg_u64 vcc, 0
    s_cbranch_scc0 Lpok_39
    s_sub_u32 s44, s44, 1
    s_cbranch_scc0 Lpoll_38
Lpok_39:
    s_lshl_b32 s60, s23, 5
    s_mul_i32 s61, s47, 798720
    s_add_u32 s60, s60, s61
    s_add_u32 s60, s60, 10747904
    v_lshrrev_b32 v102, 1, v1
    v_and_b32 v103, 1, v1
    v_mul_u32_u24 v102, 8320, v102
    v_lshl_add_u32 v102, v103, 4, v102
    s_mul_i32 s61, s47, 3072
    s_add_u32 m0, s61, 103424
    s_cmp_eq_u32 s47, 3
    buffer_load_dwordx4 v102, s[32:35], s60 offen sc1 lds
    s_cselect_b32 exec_lo, 3, -1
    s_cselect_b32 exec_hi, 0, -1
    s_add_u32 m0, m0, 1024
    s_add_u32 s60, s60, 266240
    buffer_load_dwordx4 v102, s[32:35], s60 offen sc1 lds
    s_mov_b64 exec, -1
    s_cmp_eq_u32 s47, 3
    s_cbranch_scc1 Lzdn_42
    s_add_u32 m0, m0, 1024
    s_add_u32 s60, s60, 266240
    buffer_load_dwordx4 v102, s[32:35], s60 offen sc1 lds
Lzdn_42:
    v_mov_b32 v9, 102400
    v_mov_b32 v10, 0
    v_mov_b32 v11, 0
    ds_write_b64 v9, v[10:11] offset:0
    ds_write_b64 v9, v[10:11] offset:8
    ds_write_b64 v9, v[10:11] offset:16
    ds_write_b64 v9, v[10:11] offset:24
    s_mov_b32 s36, s40
    s_mov_b32 s37, s41
    s_mov_b32 s38, 5242880
    s_mov_b32 s39, 0x20000
    s_lshl_b32 s48, s23, 1
    s_add_u32 s48, s48, s58
    v_and_b32 v2, 31, v1
    v_lshrrev_b32 v3, 5, v1
    s_lshl_b32 s60, s58, 4
    s_lshl_b32 s61, s59, 3
    s_add_u32 s60, s60, s61
    s_add_u32 s60, s60, 103424
    v_lshl_add_u32 v9, v2, 5, s60
    v_lshl_add_u32 v10, v3, 12, v9
    v_lshl_add_u32 v11, v3, 11, v9
    v_mov_b32 v7, v9
    s_mov_b32 exec_lo, 0
    v_mov_b32 v7, 196608
    s_mov_b32 exec_hi, -2
    v_mov_b32 v11, 196608
    s_mov_b64 exec, -1
    s_mul_i32 s54, s47, 2560
    s_add_u32 s54, s54, 142336
    v_mul_u32_u24 v2, 40, v2
    v_lshlrev_b32 v3, 3, v3
    v_add3_u32 v2, v2, v3, s54
    v_add_u32 v3, s54, v5
    v_add_u32 v4, 0, v1
    v_mul_u32_u24 v6, 820, v4
    v_lshrrev_b32 v6, 16, v6
    v_mul_u32_u24 v6, 80640, v6
    v_lshl_add_u32 v158, v4, 4, v6
    v_add_u32 v4, 64, v1
    v_mul_u32_u24 v6, 820, v4
    v_lshrrev_b32 v6, 16, v6
    v_mul_u32_u24 v6, 80640, v6
    v_lshl_add_u32 v159, v4, 4, v6
    v_add_u32 v4, 128, v1
    v_mul_u32_u24 v6, 820, v4
    v_lshrrev_b32 v6, 16, v6
    v_mul_u32_u24 v6, 80640, v6
    v_lshl_add_u32 v160, v4, 4, v6
    s_lshr_b32 s60, s48, 5
    s_lshl_b32 s60, s60, 7
    s_and_b32 s61, s48, 31
    s_add_u32 s60, s60, s61
    s_lshl_b32 s61, s59, 6
    s_add_u32 s60, s60, s61
    s_mul_i32 s60, s60, 2560
    s_add_u32 s60, s60, 1280
    s_waitcnt lgkmcnt(0)
    s_barrier
    v_mov_b32 v4, 102424
    v_mov_b32 v6, 1
    s_mov_b64 exec, 1
    s_waitcnt vmcnt(0)
    ds_add_u32 v4, v6
    s_mov_b64 exec, -1
    s_mov_b32 s44, 6400000
Lzw_43:
    ds_read_b32 v6, v4
    s_waitcnt lgkmcnt(0)
    v_readfirstlane_b32 s61, v6
    s_cmp_ge_u32 s61, 4
    s_cbranch_scc1 Lzgo_44
    s_sub_u32 s44, s44, 1
    s_cbranch_scc0 Lzw_43
Lzgo_44:
    ds_read_b32 v12, v10 offset:0
    ds_read_b32 v13, v10 offset:1024
    ds_read_b32 v14, v10 offset:2048
    ds_read_b32 v15, v10 offset:3072
    ds_read_b32 v16, v11 offset:8192
    ds_read_b32 v17, v7 offset:9216
    ds_read_b32 v18, v10 offset:4
    ds_read_b32 v19, v10 offset:1028
    ds_read_b32 v20, v10 offset:2052
    ds_read_b32 v21, v10 offset:3076
    ds_read_b32 v22, v11 offset:8196
    ds_read_b32 v23, v7 offset:9220
    s_waitcnt vmcnt(0) lgkmcnt(0)
    v_mfma_f32_32x32x16_bf16 v[102:117], v[12:15], v[36:39], 0
    v_mfma_f32_32x32x16_bf16 v[118:133], v[12:15], v[42:45], 0
    v_mfma_f32_32x32x8_bf16 v[102:117], v[16:17], v[40:41], v[102:117]
    v_mfma_f32_32x32x8_bf16 v[118:133], v[16:17], v[46:47], v[118:133]
    s_nop 11
    v_pk_mul_f32 v[150:151], v[102:103], v[48:49]
    v_pk_mul_f32 v[152:153], v[118:119], v[48:49]
    v_pk_fma_f32 v[150:151], v[118:119], v[64:65], v[150:151] neg_lo:[0,1,0] neg_hi:[0,1,0]
    v_pk_fma_f32 v[152:153], v[102:103], v[64:65], v[152:153]
    v_cvt_pk_bf16_f32 v134, v150, -v152
    v_cvt_pk_bf16_f32 v135, v151, -v153
    v_pk_mul_f32 v[154:155], v[104:105], v[50:51]
    v_pk_mul_f32 v[156:157], v[120:121], v[50:51]
    v_pk_fma_f32 v[154:155], v[120:121], v[66:67], v[154:155] neg_lo:[0,1,0] neg_hi:[0,1,0]
    v_pk_fma_f32 v[156:157], v[104:105], v[66:67], v[156:157]
    v_cvt_pk_bf16_f32 v136, v154, -v156
    v_cvt_pk_bf16_f32 v137, v155, -v157
    v_pk_mul_f32 v[150:151], v[106:107], v[52:53]
    v_pk_mul_f32 v[152:153], v[122:123], v[52:53]
    v_pk_fma_f32 v[150:151], v[122:123], v[68:69], v[150:151] neg_lo:[0,1,0] neg_hi:[0,1,0]
    v_pk_fma_f32 v[152:153], v[106:107], v[68:69], v[152:153]
    v_cvt_pk_bf16_f32 v138, v150, -v152
    v_cvt_pk_bf16_f32 v139, v151, -v153
    v_pk_mul_f32 v[154:155], v[108:109], v[54:55]
    v_pk_mul_f32 v[156:157], v[124:125], v[54:55]
    v_pk_fma_f32 v[154:155], v[124:125], v[70:71], v[154:155] neg_lo:[0,1,0] neg_hi:[0,1,0]
    v_pk_fma_f32 v[156:157], v[108:109], v[70:71], v[156:157]
    v_cvt_pk_bf16_f32 v140, v154, -v156
    v_cvt_pk_bf16_f32 v141, v155, -v157
    v_pk_mul_f32 v[150:151], v[110:111], v[56:57]
    v_pk_mul_f32 v[152:153], v[126:127], v[56:57]
    v_pk_fma_f32 v[150:151], v[126:127], v[72:73], v[150:151] neg_lo:[0,1,0] neg_hi:[0,1,0]
    v_pk_fma_f32 v[152:153], v[110:111], v[72:73], v[152:153]
    v_cvt_pk_bf16_f32 v142, v150, -v152
    v_cvt_pk_bf16_f32 v143, v151, -v153
    v_pk_mul_f32 v[154:155], v[112:113], v[58:59]
    v_pk_mul_f32 v[156:157], v[128:129], v[58:59]
    v_pk_fma_f32 v[154:155], v[128:129], v[74:75], v[154:155] neg_lo:[0,1,0] neg_hi:[0,1,0]
    v_pk_fma_f32 v[156:157], v[112:113], v[74:75], v[156:157]
    v_cvt_pk_bf16_f32 v144, v154, -v156
    v_cvt_pk_bf16_f32 v145, v155, -v157
    v_pk_mul_f32 v[150:151], v[114:115], v[60:61]
    v_pk_mul_f32 v[152:153], v[130:131], v[60:61]
    v_pk_fma_f32 v[150:151], v[130:131], v[76:77], v[150:151] neg_lo:[0,1,0] neg_hi:[0,1,0]
    v_pk_fma_f32 v[152:153], v[114:115], v[76:77], v[152:153]
    v_cvt_pk_bf16_f32 v146, v150, -v152
    v_cvt_pk_bf16_f32 v147, v151, -v153
    v_pk_mul_f32 v[154:155], v[116:117], v[62:63]
    v_pk_mul_f32 v[156:157], v[132:133], v[62:63]
    v_pk_fma_f32 v[154:155], v[132:133], v[78:79], v[154:155] neg_lo:[0,1,0] neg_hi:[0,1,0]
    v_pk_fma_f32 v[156:157], v[116:117], v[78:79], v[156:157]
    v_cvt_pk_bf16_f32 v148, v154, -v156
    v_cvt_pk_bf16_f32 v149, v155, -v157
    s_nop 1
    v_mfma_f32_32x32x16_bf16 v[102:117], v[134:137], v[80:83], 0
    v_mfma_f32_32x32x16_bf16 v[102:117], v[138:141], v[84:87], v[102:117]
    v_mfma_f32_32x32x16_bf16 v[102:117], v[142:145], v[88:91], v[102:117]
    v_mfma_f32_32x32x16_bf16 v[102:117], v[146:149], v[92:95], v[102:117]
    s_nop 11
    v_cvt_pk_bf16_f32 v150, v102, v103
    v_cvt_pk_bf16_f32 v151, v104, v105
    v_cvt_pk_bf16_f32 v152, v106, v107
    v_cvt_pk_bf16_f32 v153, v108, v109
    v_cvt_pk_bf16_f32 v154, v110, v111
    v_cvt_pk_bf16_f32 v155, v112, v113
    ds_write_b64 v2, v[150:151] offset:0
    ds_write_b64 v2, v[152:153] offset:16
    s_mov_b32 exec_hi, 0
    ds_write_b64 v2, v[154:155] offset:32
    s_mov_b32 exec_hi, -1
    v_mfma_f32_32x32x16_bf16 v[102:117], v[18:21], v[36:39], 0
    v_mfma_f32_32x32x16_bf16 v[118:133], v[18:21], v[42:45], 0
    v_mfma_f32_32x32x8_bf16 v[102:117], v[22:23], v[40:41], v[102:117]
    v_mfma_f32_32x32x8_bf16 v[118:133], v[22:23], v[46:47], v[118:133]
    s_nop 11
    v_pk_mul_f32 v[150:151], v[102:103], v[48:49]
    v_pk_mul_f32 v[152:153], v[118:119], v[48:49]
    v_pk_fma_f32 v[150:151], v[118:119], v[64:65], v[150:151] neg_lo:[0,1,0] neg_hi:[0,1,0]
    v_pk_fma_f32 v[152:153], v[102:103], v[64:65], v[152:153]
    v_cvt_pk_bf16_f32 v134, v150, -v152
    v_cvt_pk_bf16_f32 v135, v151, -v153
    v_pk_mul_f32 v[154:155], v[104:105], v[50:51]
    v_pk_mul_f32 v[156:157], v[120:121], v[50:51]
    v_pk_fma_f32 v[154:155], v[120:121], v[66:67], v[154:155] neg_lo:[0,1,0] neg_hi:[0,1,0]
    v_pk_fma_f32 v[156:157], v[104:105], v[66:67], v[156:157]
    v_cvt_pk_bf16_f32 v136, v154, -v156
    v_cvt_pk_bf16_f32 v137, v155, -v157
    v_pk_mul_f32 v[150:151], v[106:107], v[52:53]
    v_pk_mul_f32 v[152:153], v[122:123], v[52:53]
    v_pk_fma_f32 v[150:151], v[122:123], v[68:69], v[150:151] neg_lo:[0,1,0] neg_hi:[0,1,0]
    v_pk_fma_f32 v[152:153], v[106:107], v[68:69], v[152:153]
    v_cvt_pk_bf16_f32 v138, v150, -v152
    v_cvt_pk_bf16_f32 v139, v151, -v153
    v_pk_mul_f32 v[154:155], v[108:109], v[54:55]
    v_pk_mul_f32 v[156:157], v[124:125], v[54:55]
    v_pk_fma_f32 v[154:155], v[124:125], v[70:71], v[154:155] neg_lo:[0,1,0] neg_hi:[0,1,0]
    v_pk_fma_f32 v[156:157], v[108:109], v[70:71], v[156:157]
    v_cvt_pk_bf16_f32 v140, v154, -v156
    v_cvt_pk_bf16_f32 v141, v155, -v157
    v_pk_mul_f32 v[150:151], v[110:111], v[56:57]
    v_pk_mul_f32 v[152:153], v[126:127], v[56:57]
    v_pk_fma_f32 v[150:151], v[126:127], v[72:73], v[150:151] neg_lo:[0,1,0] neg_hi:[0,1,0]
    v_pk_fma_f32 v[152:153], v[110:111], v[72:73], v[152:153]
    v_cvt_pk_bf16_f32 v142, v150, -v152
    v_cvt_pk_bf16_f32 v143, v151, -v153
    v_pk_mul_f32 v[154:155], v[112:113], v[58:59]
    v_pk_mul_f32 v[156:157], v[128:129], v[58:59]
    v_pk_fma_f32 v[154:155], v[128:129], v[74:75], v[154:155] neg_lo:[0,1,0] neg_hi:[0,1,0]
    v_pk_fma_f32 v[156:157], v[112:113], v[74:75], v[156:157]
    v_cvt_pk_bf16_f32 v144, v154, -v156
    v_cvt_pk_bf16_f32 v145, v155, -v157
    v_pk_mul_f32 v[150:151], v[114:115], v[60:61]
    v_pk_mul_f32 v[152:153], v[130:131], v[60:61]
    v_pk_fma_f32 v[150:151], v[130:131], v[76:77], v[150:151] neg_lo:[0,1,0] neg_hi:[0,1,0]
    v_pk_fma_f32 v[152:153], v[114:115], v[76:77], v[152:153]
    v_cvt_pk_bf16_f32 v146, v150, -v152
    v_cvt_pk_bf16_f32 v147, v151, -v153
    v_pk_mul_f32 v[154:155], v[116:117], v[62:63]
    v_pk_mul_f32 v[156:157], v[132:133], v[62:63]
    v_pk_fma_f32 v[154:155], v[132:133], v[78:79], v[154:155] neg_lo:[0,1,0] neg_hi:[0,1,0]
    v_pk_fma_f32 v[156:157], v[116:117], v[78:79], v[156:157]
    v_cvt_pk_bf16_f32 v148, v154, -v156
    v_cvt_pk_bf16_f32 v149, v155, -v157
    s_nop 1
    v_mfma_f32_32x32x16_bf16 v[102:117], v[134:137], v[80:83], 0
    v_mfma_f32_32x32x16_bf16 v[102:117], v[138:141], v[84:87], v[102:117]
    v_mfma_f32_32x32x16_bf16 v[102:117], v[142:145], v[88:91], v[102:117]
    v_mfma_f32_32x32x16_bf16 v[102:117], v[146:149], v[92:95], v[102:117]
    s_nop 11
    v_cvt_pk_bf16_f32 v150, v102, v103
    v_cvt_pk_bf16_f32 v151, v104, v105
    v_cvt_pk_bf16_f32 v152, v106, v107
    v_cvt_pk_bf16_f32 v153, v108, v109
    v_cvt_pk_bf16_f32 v154, v110, v111
    v_cvt_pk_bf16_f32 v155, v112, v113
    ds_write_b64 v2, v[150:151] offset:1280
    ds_write_b64 v2, v[152:153] offset:1296
    s_mov_b32 exec_hi, 0
    ds_write_b64 v2, v[154:155] offset:1312
    s_mov_b32 exec_hi, -1
    ds_read_b128 v[12:15], v3 offset:0
    ds_read_b128 v[16:19], v3 offset:1024
    s_mov_b32 exec_hi, 0
    ds_read_b128 v[20:23], v3 offset:2048
    s_mov_b32 exec_hi, -1
    s_waitcnt lgkmcnt(2)
    buffer_store_dwordx4 v[12:15], v158, s[36:39], s60 offen nt
    s_waitcnt lgkmcnt(1)
    buffer_store_dwordx4 v[16:19], v159, s[36:39], s60 offen nt
    s_mov_b32 exec_hi, 0
    s_waitcnt lgkmcnt(0)
    buffer_store_dwordx4 v[20:23], v160, s[36:39], s60 offen nt
    s_endpgm
Lattn_1:
    s_waitcnt lgkmcnt(0)
    s_mov_b32 s32, s20
    s_mov_b32 s33, s21
    s_mov_b32 s34, 14286848
    s_mov_b32 s35, 0x20000
    v_lshlrev_b32 v166, 7, v1
    s_cmp_lg_u32 s22, 6
    s_cbranch_scc1 Lwarm_45
    s_mov_b32 s36, s6
    s_mov_b32 s37, s7
    s_mov_b32 s38, 819200
    s_mov_b32 s39, 0x20000
    s_mul_i32 s60, s23, 3200
    s_mov_b32 exec_lo, 0x1ffffff
    s_mov_b32 exec_hi, 0x0
    buffer_load_dword v167, v166, s[36:39], s60 offen
    s_mov_b64 exec, -1
Lwarm_45:
    s_cmp_lg_u32 s22, 4
    s_cbranch_scc1 Lwarm_46
    s_mov_b32 s36, s8
    s_mov_b32 s37, s9
    s_mov_b32 s38, 25600
    s_mov_b32 s39, 0x20000
    s_lshl_b32 s60, s23, 7
    s_mov_b32 exec_lo, 0x1
    s_mov_b32 exec_hi, 0x0
    buffer_load_dword v167, v166, s[36:39], s60 offen
    s_mov_b64 exec, -1
Lwarm_46:
    s_cmp_lg_u32 s22, 5
    s_cbranch_scc1 Lwarm_47
    s_mov_b32 s36, s10
    s_mov_b32 s37, s11
    s_mov_b32 s38, 25600
    s_mov_b32 s39, 0x20000
    s_lshl_b32 s60, s23, 7
    s_mov_b32 exec_lo, 0x1
    s_mov_b32 exec_hi, 0x0
    buffer_load_dword v167, v166, s[36:39], s60 offen
    s_mov_b64 exec, -1
Lwarm_47:
    s_cmp_lg_u32 s22, 3
    s_cbranch_scc1 Lwarm_48
    s_mov_b32 s36, s12
    s_mov_b32 s37, s13
    s_mov_b32 s38, 819200
    s_mov_b32 s39, 0x20000
    s_mul_i32 s60, s23, 3200
    s_mov_b32 exec_lo, 0x1ffffff
    s_mov_b32 exec_hi, 0x0
    buffer_load_dword v167, v166, s[36:39], s60 offen
    s_mov_b64 exec, -1
Lwarm_48:
    s_setprio 2
    v_and_b32 v2, 31, v1
    v_lshrrev_b32 v3, 5, v1
    v_and_b32 v4, 15, v1
    v_xor_b32 v6, v4, v3
    s_and_b32 s60, s22, 1
    s_lshl_b32 s60, s60, 13
    v_lshl_add_u32 v7, v2, 8, s60
    v_lshl_add_u32 v12, v6, 4, v7
    v_xor_b32 v13, 32, v12
    v_xor_b32 v14, 64, v12
    v_xor_b32 v15, 96, v12
    v_xor_b32 v16, 128, v12
    v_xor_b32 v17, 160, v12
    v_xor_b32 v18, 192, v12
    v_xor_b32 v19, 224, v12
    v_add_u32 v20, 99328, v12
    v_add_u32 v21, 99328, v13
    v_add_u32 v22, 99328, v14
    v_add_u32 v23, 99328, v15
    v_add_u32 v24, 99328, v16
    v_add_u32 v25, 99328, v17
    v_add_u32 v26, 99328, v18
    v_add_u32 v27, 99328, v19
    v_lshrrev_b32 v6, 2, v4
    v_lshl_add_u32 v6, v3, 2, v6
    v_mul_u32_u24 v6, 320, v6
    v_and_b32 v7, 3, v1
    v_lshl_add_u32 v6, v7, 3, v6
    v_and_b32 v7, 16, v1
    v_lshl_add_u32 v6, v7, 1, v6
    v_and_b32 v7, 19, v1
    v_cmp_lt_u32 vcc, 16, v7
    v_mov_b32 v7, 196608
    s_nop 0
    v_cndmask_b32 v6, v6, v7, vcc
    s_lshr_b32 s60, s22, 1
    s_mul_i32 s60, s60, 40
    v_add_u32 v30, s60, v6
    v_add_u32 v28, 43008, v30
    v_add_u32 v29, 115712, v30
    s_and_b32 s61, s22, 1
    s_mul_i32 s68, s61, 5120
    s_add_u32 s68, s68, 99328
    v_add_u32 v160, s68, v5
    v_lshl_add_u32 v161, v1, 3, s68
    s_mul_i32 s68, s61, 5632
    s_add_u32 s68, s68, 109568
    v_and_b32 v9, 31, v1
    v_lshrrev_b32 v10, 5, v1
    v_mul_u32_u24 v10, 352, v10
    v_lshl_add_u32 v10, v9, 4, v10
    v_add_u32 v10, s68, v10
    v_cmp_lt_u32 vcc, 20, v9
    v_mov_b32 v9, 196608
    v_mov_b32 v52, 0
    v_mov_b32 v53, 0
    v_mov_b32 v54, 0
    v_mov_b32 v55, 0
    v_mov_b32 v56, 0
    v_mov_b32 v57, 0
    v_mov_b32 v58, 0
    v_mov_b32 v59, 0
    v_mov_b32 v60, 0
    v_mov_b32 v61, 0
    v_mov_b32 v62, 0
    v_mov_b32 v63, 0
    v_mov_b32 v64, 0
    v_mov_b32 v65, 0
    v_mov_b32 v66, 0
    v_mov_b32 v67, 0
    v_mov_b32 v68, 0
    v_mov_b32 v69, 0
    v_mov_b32 v70, 0
    v_mov_b32 v71, 0
    v_mov_b32 v72, 0
    v_mov_b32 v73, 0
    v_mov_b32 v74, 0
    v_mov_b32 v75, 0
    v_mov_b32 v76, 0
    v_mov_b32 v77, 0
    v_mov_b32 v78, 0
    v_mov_b32 v79, 0
    v_mov_b32 v80, 0
    v_mov_b32 v81, 0
    v_mov_b32 v82, 0
    v_mov_b32 v83, 0
    v_cndmask_b32 v162, v10, v9, vcc
    s_mul_i32 s60, s22, 1536
    s_add_u32 s60, s60, 20480
    v_add_u32 v31, s60, v5
    v_lshl_add_u32 v32, v1, 3, s60
    s_xor_b32 s61, s22, 1
    s_mul_i32 s61, s61, 1536
    s_add_u32 s61, s61, 20480
    v_add_u32 v163, s61, v5
    s_sub_u32 s60, s60, s61
    v_and_b32 v7, 31, v1
    v_lshrrev_b32 v8, 5, v1
    v_mul_lo_u32 v8, s60, v8
    v_lshl_add_u32 v7, v7, 3, v8
    v_add_u32 v159, s61, v7
    s_xor_b32 s60, s22, 1
    s_mul_i32 s60, s60, 3072
    s_add_u32 s60, s60, 117760
    v_add_u32 v157, s60, v5
    s_mul_i32 s60, s22, 3072
    s_add_u32 s60, s60, 117760
    v_add_u32 v158, s60, v5
    s_lshl_b32 s62, s65, 1
    s_and_b32 s60, s22, 1
    s_add_u32 s62, s62, s60
    s_lshl_b32 s62, s62, 9
    s_mul_i32 s60, s64, 339200
    s_add_u32 s62, s62, s60
    s_add_u32 s62, s62, 2097152
    s_lshr_b32 s60, s22, 2
    s_mul_i32 s63, s60, 33920
    s_add_u32 s63, s63, s62
    s_add_u32 s63, s63, 271360
    s_bfe_u32 s61, s22, 0x10001
    s_xor_b32 s60, s60, s61
    s_lshl_b32 s60, s60, 3
    s_add_u32 s63, s63, s60
    s_lshr_b32 s60, s22, 1
    s_mul_i32 s60, s60, 67840
    s_add_u32 s62, s62, s60
    s_cmp_ge_u32 s64, 4
    s_cbranch_scc1 Lnokv_50
    s_cmp_ge_u32 s22, 4
    s_cbranch_scc1 Lnokv_50
    s_cmp_ge_u32 s64, 2
    s_cbranch_scc1 Lv_49
    v_and_b32 v2, 15, v1
    v_lshrrev_b32 v3, 4, v1
    s_and_b32 s60, s64, 1
    s_lshl_b32 s60, s60, 1
    s_and_b32 s61, s22, 1
    s_add_u32 s60, s60, s61
    s_lshl_b32 s68, s65, 2
    s_add_u32 s68, s68, s60
    s_lshl_b32 s60, s60, 12
    v_xor_b32 v4, v2, v3
    v_lshl_add_u32 v6, v2, 8, s60
    v_lshl_add_u32 v148, v4, 4, v6
    v_xor_b32 v149, 64, v148
    v_xor_b32 v150, 128, v148
    v_xor_b32 v151, 192, v148
    v_add_u32 v152, 99328, v148
    v_add_u32 v153, 99328, v149
    v_add_u32 v154, 99328, v150
    v_add_u32 v155, 99328, v151
    v_lshrrev_b32 v4, 2, v2
    v_lshl_add_u32 v4, v3, 3, v4
    v_mul_u32_u24 v4, 40, v4
    s_lshr_b32 s69, s22, 1
    s_cmp_eq_u32 s69, 0
    s_cselect_b32 s61, 3, 0
    v_and_b32 v6, s61, v2
    v_lshl_add_u32 v4, v6, 3, v4
    s_lshl_b32 s61, s69, 5
    s_add_u32 s61, s61, 43008
    v_add_u32 v156, s61, v4
    s_barrier
    ds_read_b128 v[84:87], v148 offset:0
    ds_read_b64_tr_b16 v[88:89], v156 offset:0
    ds_read_b64_tr_b16 v[90:91], v156 offset:160
    ds_read_b128 v[92:95], v149 offset:0
    ds_read_b64_tr_b16 v[96:97], v156 offset:1280
    ds_read_b64_tr_b16 v[98:99], v156 offset:1440
    ds_read_b128 v[100:103], v150 offset:0
    ds_read_b64_tr_b16 v[104:105], v156 offset:2560
    ds_read_b64_tr_b16 v[106:107], v156 offset:2720
    ds_read_b128 v[108:111], v151 offset:0
    ds_read_b64_tr_b16 v[112:113], v156 offset:3840
    ds_read_b64_tr_b16 v[114:115], v156 offset:4000
    ds_read_b128 v[116:119], v148 offset:16384
    ds_read_b64_tr_b16 v[120:121], v156 offset:5120
    ds_read_b64_tr_b16 v[122:123], v156 offset:5280
    s_waitcnt lgkmcnt(12)
    v_mfma_f32_16x16x32_bf16 v[36:39], v[88:91], v[84:87], 0
    ds_read_b128 v[124:127], v149 offset:16384
    ds_read_b64_tr_b16 v[128:129], v156 offset:6400
    ds_read_b64_tr_b16 v[130:131], v156 offset:6560
    s_waitcnt lgkmcnt(12)
    v_mfma_f32_16x16x32_bf16 v[40:43], v[96:99], v[92:95], 0
    ds_read_b128 v[132:135], v150 offset:16384
    ds_read_b64_tr_b16 v[136:137], v156 offset:7680
    ds_read_b64_tr_b16 v[138:139], v156 offset:7840
    s_waitcnt lgkmcnt(12)
    v_mfma_f32_16x16x32_bf16 v[36:39], v[104:107], v[100:103], v[36:39]
    ds_read_b128 v[140:143], v151 offset:16384
    ds_read_b64_tr_b16 v[144:145], v156 offset:8960
    ds_read_b64_tr_b16 v[146:147], v156 offset:9120
    s_waitcnt lgkmcnt(12)
    v_mfma_f32_16x16x32_bf16 v[40:43], v[112:115], v[108:111], v[40:43]
    ds_read_b128 v[84:87], v152 offset:0
    ds_read_b64_tr_b16 v[88:89], v156 offset:10240
    ds_read_b64_tr_b16 v[90:91], v156 offset:10400
    s_waitcnt lgkmcnt(12)
    v_mfma_f32_16x16x32_bf16 v[36:39], v[120:123], v[116:119], v[36:39]
    ds_read_b128 v[92:95], v153 offset:0
    ds_read_b64_tr_b16 v[96:97], v156 offset:11520
    ds_read_b64_tr_b16 v[98:99], v156 offset:11680
    s_waitcnt lgkmcnt(12)
    v_mfma_f32_16x16x32_bf16 v[40:43], v[128:131], v[124:127], v[40:43]
    ds_read_b128 v[100:103], v154 offset:0
    ds_read_b64_tr_b16 v[104:105], v156 offset:12800
    ds_read_b64_tr_b16 v[106:107], v156 offset:12960
    s_waitcnt lgkmcnt(12)
    v_mfma_f32_16x16x32_bf16 v[36:39], v[136:139], v[132:135], v[36:39]
    ds_read_b128 v[108:111], v155 offset:0
    ds_read_b64_tr_b16 v[112:113], v156 offset:14080
    ds_read_b64_tr_b16 v[114:115], v156 offset:14240
    s_waitcnt lgkmcnt(12)
    v_mfma_f32_16x16x32_bf16 v[40:43], v[144:147], v[140:143], v[40:43]
    s_waitcnt lgkmcnt(9)
    v_mfma_f32_16x16x32_bf16 v[36:39], v[88:91], v[84:87], v[36:39]
    s_waitcnt lgkmcnt(6)
    v_mfma_f32_16x16x32_bf16 v[40:43], v[96:99], v[92:95], v[40:43]
    s_waitcnt lgkmcnt(3)
    v_mfma_f32_16x16x32_bf16 v[36:39], v[104:107], v[100:103], v[36:39]
    s_waitcnt lgkmcnt(0)
    v_mfma_f32_16x16x32_bf16 v[40:43], v[112:115], v[108:111], v[40:43]
    s_barrier
    ds_read_b128 v[116:119], v152 offset:26624
    ds_read_b64_tr_b16 v[120:121], v156 offset:15360
    ds_read_b64_tr_b16 v[122:123], v156 offset:15520
    ds_read_b128 v[124:127], v153 offset:26624
    ds_read_b64_tr_b16 v[128:129], v156 offset:16640
    ds_read_b64_tr_b16 v[130:131], v156 offset:16800
    ds_read_b128 v[132:135], v154 offset:26624
    ds_read_b64_tr_b16 v[136:137], v156 offset:17920
    ds_read_b64_tr_b16 v[138:139], v156 offset:18080
    ds_read_b128 v[140:143], v155 offset:26624
    ds_read_b64_tr_b16 v[144:145], v156 offset:19200
    ds_read_b64_tr_b16 v[146:147], v156 offset:19360
    ds_read_b128 v[84:87], v152 offset:43008
    ds_read_b64_tr_b16 v[88:89], v156 offset:20480
    ds_read_b64_tr_b16 v[90:91], v156 offset:20640
    s_waitcnt lgkmcnt(12)
    v_mfma_f32_16x16x32_bf16 v[36:39], v[120:123], v[116:119], v[36:39]
    ds_read_b128 v[92:95], v153 offset:43008
    ds_read_b64_tr_b16 v[96:97], v156 offset:21760
    ds_read_b64_tr_b16 v[98:99], v156 offset:21920
    s_waitcnt lgkmcnt(12)
    v_mfma_f32_16x16x32_bf16 v[40:43], v[128:131], v[124:127], v[40:43]
    ds_read_b128 v[100:103], v154 offset:43008
    ds_read_b64_tr_b16 v[104:105], v156 offset:23040
    ds_read_b64_tr_b16 v[106:107], v156 offset:23200
    s_waitcnt lgkmcnt(12)
    v_mfma_f32_16x16x32_bf16 v[36:39], v[136:139], v[132:135], v[36:39]
    ds_read_b128 v[108:111], v155 offset:43008
    ds_read_b64_tr_b16 v[112:113], v156 offset:24320
    ds_read_b64_tr_b16 v[114:115], v156 offset:24480
    s_waitcnt lgkmcnt(12)
    v_mfma_f32_16x16x32_bf16 v[40:43], v[144:147], v[140:143], v[40:43]
    s_waitcnt lgkmcnt(9)
    v_mfma_f32_16x16x32_bf16 v[36:39], v[88:91], v[84:87], v[36:39]
    s_waitcnt lgkmcnt(6)
    v_mfma_f32_16x16x32_bf16 v[40:43], v[96:99], v[92:95], v[40:43]
    s_waitcnt lgkmcnt(3)
    v_mfma_f32_16x16x32_bf16 v[36:39], v[104:107], v[100:103], v[36:39]
    s_waitcnt lgkmcnt(0)
    v_mfma_f32_16x16x32_bf16 v[40:43], v[112:115], v[108:111], v[40:43]
    s_nop 7
    v_add_f32 v36, v36, v40
    v_add_f32 v37, v37, v41
    v_add_f32 v38, v38, v42
    v_add_f32 v39, v39, v43
    s_bfe_u32 s60, s68, 0x30003
    s_mul_i32 s60, s60, 21504
    s_lshr_b32 s61, s68, 6
    s_lshl_b32 s61, s61, 1
    s_bfe_u32 s44, s68, 0x10002
    s_add_u32 s61, s61, s44
    s_mul_i32 s61, s61, 2560
    s_add_u32 s60, s60, s61
    s_add_u32 s60, s60, 13500416
    s_bfe_u32 s61, s68, 0x10001
    s_and_b32 s68, s68, 1
    v_cvt_pk_bf16_f32 v8, v36, v37
    v_cvt_pk_bf16_f32 v9, v38, v39
    s_cmp_eq_u32 s69, 1
    s_cbranch_scc1 Lt1_52
    s_lshl_b32 s61, s61, 10
    s_lshl_b32 s68, s68, 8
    s_add_u32 s60, s60, s61
    s_add_u32 s60, s60, s68
    v_and_b32 v4, 1, v3
    v_lshlrev_b32 v4, 9, v4
    v_lshl_add_u32 v4, v2, 4, v4
    v_lshrrev_b32 v3, 1, v3
    v_lshl_add_u32 v4, v3, 3, v4
    buffer_store_dwordx2 v[8:9], v4, s[32:35], s60 offen sc1
    s_branch Lkvd_53
Lt1_52:
    s_lshl_b32 s61, s61, 8
    s_lshl_b32 s68, s68, 7
    s_add_u32 s60, s60, s61
    s_add_u32 s60, s60, s68
    v_lshlrev_b32 v4, 3, v2
    s_mov_b64 exec, 0xffff
    buffer_store_dwordx2 v[8:9], v4, s[32:35], s60 offen offset:2048 sc1
Lkvd_53:
    s_mov_b64 exec, -1
    s_barrier
    s_branch Lj_51
Lv_49:
    v_and_b32 v2, 15, v1
    v_lshrrev_b32 v3, 4, v1
    s_and_b32 s60, s64, 1
    s_lshl_b32 s60, s60, 1
    s_and_b32 s61, s22, 1
    s_add_u32 s60, s60, s61
    s_lshl_b32 s68, s65, 2
    s_add_u32 s68, s68, s60
    s_lshl_b32 s60, s60, 12
    v_xor_b32 v4, v2, v3
    v_lshl_add_u32 v6, v2, 8, s60
    v_lshl_add_u32 v148, v4, 4, v6
    v_xor_b32 v149, 64, v148
    v_xor_b32 v150, 128, v148
    v_xor_b32 v151, 192, v148
    v_add_u32 v152, 99328, v148
    v_add_u32 v153, 99328, v149
    v_add_u32 v154, 99328, v150
    v_add_u32 v155, 99328, v151
    v_lshrrev_b32 v4, 2, v2
    v_lshl_add_u32 v4, v3, 3, v4
    v_mul_u32_u24 v4, 40, v4
    s_lshr_b32 s69, s22, 1
    s_cmp_eq_u32 s69, 0
    s_cselect_b32 s61, 3, 0
    v_and_b32 v6, s61, v2
    v_lshl_add_u32 v4, v6, 3, v4
    s_lshl_b32 s61, s69, 5
    s_add_u32 s61, s61, 43008
    v_add_u32 v156, s61, v4
    s_barrier
    ds_read_b128 v[84:87], v148 offset:0
    ds_read_b64_tr_b16 v[88:89], v156 offset:0
    ds_read_b64_tr_b16 v[90:91], v156 offset:160
    ds_read_b128 v[92:95], v149 offset:0
    ds_read_b64_tr_b16 v[96:97], v156 offset:1280
    ds_read_b64_tr_b16 v[98:99], v156 offset:1440
    ds_read_b128 v[100:103], v150 offset:0
    ds_read_b64_tr_b16 v[104:105], v156 offset:2560
    ds_read_b64_tr_b16 v[106:107], v156 offset:2720
    ds_read_b128 v[108:111], v151 offset:0
    ds_read_b64_tr_b16 v[112:113], v156 offset:3840
    ds_read_b64_tr_b16 v[114:115], v156 offset:4000
    ds_read_b128 v[116:119], v148 offset:16384
    ds_read_b64_tr_b16 v[120:121], v156 offset:5120
    ds_read_b64_tr_b16 v[122:123], v156 offset:5280
    s_waitcnt lgkmcnt(12)
    v_mfma_f32_16x16x32_bf16 v[36:39], v[84:87], v[88:91], 0
    ds_read_b128 v[124:127], v149 offset:16384
    ds_read_b64_tr_b16 v[128:129], v156 offset:6400
    ds_read_b64_tr_b16 v[130:131], v156 offset:6560
    s_waitcnt lgkmcnt(12)
    v_mfma_f32_16x16x32_bf16 v[40:43], v[92:95], v[96:99], 0
    ds_read_b128 v[132:135], v150 offset:16384
    ds_read_b64_tr_b16 v[136:137], v156 offset:7680
    ds_read_b64_tr_b16 v[138:139], v156 offset:7840
    s_waitcnt lgkmcnt(12)
    v_mfma_f32_16x16x32_bf16 v[36:39], v[100:103], v[104:107], v[36:39]
    ds_read_b128 v[140:143], v151 offset:16384
    ds_read_b64_tr_b16 v[144:145], v156 offset:8960
    ds_read_b64_tr_b16 v[146:147], v156 offset:9120
    s_waitcnt lgkmcnt(12)
    v_mfma_f32_16x16x32_bf16 v[40:43], v[108:111], v[112:115], v[40:43]
    ds_read_b128 v[84:87], v152 offset:0
    ds_read_b64_tr_b16 v[88:89], v156 offset:10240
    ds_read_b64_tr_b16 v[90:91], v156 offset:10400
    s_waitcnt lgkmcnt(12)
    v_mfma_f32_16x16x32_bf16 v[36:39], v[116:119], v[120:123], v[36:39]
    ds_read_b128 v[92:95], v153 offset:0
    ds_read_b64_tr_b16 v[96:97], v156 offset:11520
    ds_read_b64_tr_b16 v[98:99], v156 offset:11680
    s_waitcnt lgkmcnt(12)
    v_mfma_f32_16x16x32_bf16 v[40:43], v[124:127], v[128:131], v[40:43]
    ds_read_b128 v[100:103], v154 offset:0
    ds_read_b64_tr_b16 v[104:105], v156 offset:12800
    ds_read_b64_tr_b16 v[106:107], v156 offset:12960
    s_waitcnt lgkmcnt(12)
    v_mfma_f32_16x16x32_bf16 v[36:39], v[132:135], v[136:139], v[36:39]
    ds_read_b128 v[108:111], v155 offset:0
    ds_read_b64_tr_b16 v[112:113], v156 offset:14080
    ds_read_b64_tr_b16 v[114:115], v156 offset:14240
    s_waitcnt lgkmcnt(12)
    v_mfma_f32_16x16x32_bf16 v[40:43], v[140:143], v[144:147], v[40:43]
    s_waitcnt lgkmcnt(9)
    v_mfma_f32_16x16x32_bf16 v[36:39], v[84:87], v[88:91], v[36:39]
    s_waitcnt lgkmcnt(6)
    v_mfma_f32_16x16x32_bf16 v[40:43], v[92:95], v[96:99], v[40:43]
    s_waitcnt lgkmcnt(3)
    v_mfma_f32_16x16x32_bf16 v[36:39], v[100:103], v[104:107], v[36:39]
    s_waitcnt lgkmcnt(0)
    v_mfma_f32_16x16x32_bf16 v[40:43], v[108:111], v[112:115], v[40:43]
    s_barrier
    ds_read_b128 v[116:119], v152 offset:26624
    ds_read_b64_tr_b16 v[120:121], v156 offset:15360
    ds_read_b64_tr_b16 v[122:123], v156 offset:15520
    ds_read_b128 v[124:127], v153 offset:26624
    ds_read_b64_tr_b16 v[128:129], v156 offset:16640
    ds_read_b64_tr_b16 v[130:131], v156 offset:16800
    ds_read_b128 v[132:135], v154 offset:26624
    ds_read_b64_tr_b16 v[136:137], v156 offset:17920
    ds_read_b64_tr_b16 v[138:139], v156 offset:18080
    ds_read_b128 v[140:143], v155 offset:26624
    ds_read_b64_tr_b16 v[144:145], v156 offset:19200
    ds_read_b64_tr_b16 v[146:147], v156 offset:19360
    ds_read_b128 v[84:87], v152 offset:43008
    ds_read_b64_tr_b16 v[88:89], v156 offset:20480
    ds_read_b64_tr_b16 v[90:91], v156 offset:20640
    s_waitcnt lgkmcnt(12)
    v_mfma_f32_16x16x32_bf16 v[36:39], v[116:119], v[120:123], v[36:39]
    ds_read_b128 v[92:95], v153 offset:43008
    ds_read_b64_tr_b16 v[96:97], v156 offset:21760
    ds_read_b64_tr_b16 v[98:99], v156 offset:21920
    s_waitcnt lgkmcnt(12)
    v_mfma_f32_16x16x32_bf16 v[40:43], v[124:127], v[128:131], v[40:43]
    ds_read_b128 v[100:103], v154 offset:43008
    ds_read_b64_tr_b16 v[104:105], v156 offset:23040
    ds_read_b64_tr_b16 v[106:107], v156 offset:23200
    s_waitcnt lgkmcnt(12)
    v_mfma_f32_16x16x32_bf16 v[36:39], v[132:135], v[136:139], v[36:39]
    ds_read_b128 v[108:111], v155 offset:43008
    ds_read_b64_tr_b16 v[112:113], v156 offset:24320
    ds_read_b64_tr_b16 v[114:115], v156 offset:24480
    s_waitcnt lgkmcnt(12)
    v_mfma_f32_16x16x32_bf16 v[40:43], v[140:143], v[144:147], v[40:43]
    s_waitcnt lgkmcnt(9)
    v_mfma_f32_16x16x32_bf16 v[36:39], v[84:87], v[88:91], v[36:39]
    s_waitcnt lgkmcnt(6)
    v_mfma_f32_16x16x32_bf16 v[40:43], v[92:95], v[96:99], v[40:43]
    s_waitcnt lgkmcnt(3)
    v_mfma_f32_16x16x32_bf16 v[36:39], v[100:103], v[104:107], v[36:39]
    s_waitcnt lgkmcnt(0)
    v_mfma_f32_16x16x32_bf16 v[40:43], v[108:111], v[112:115], v[40:43]
    s_nop 7
    v_add_f32 v36, v36, v40
    v_add_f32 v37, v37, v41
    v_add_f32 v38, v38, v42
    v_add_f32 v39, v39, v43
    s_and_b32 s61, s68, 63
    s_add_u32 s61, s61, 3
    s_lshr_b32 s60, s61, 3
    s_mul_i32 s60, s60, 21504
    s_and_b32 s61, s61, 7
    s_lshr_b32 s44, s68, 6
    s_lshl_b32 s44, s44, 3
    s_add_u32 s61, s61, s44
    s_mul_i32 s61, s61, 704
    s_add_u32 s60, s60, s61
    s_add_u32 s60, s60, 13510656
    v_and_b32 v4, 1, v3
    v_mul_u32_u24 v4, 352, v4
    v_lshl_add_u32 v4, v2, 4, v4
    v_lshrrev_b32 v3, 1, v3
    v_lshl_add_u32 v4, v3, 3, v4
    v_cvt_pk_bf16_f32 v8, v36, v37
    v_cvt_pk_bf16_f32 v9, v38, v39
    s_cmp_eq_u32 s69, 1
    s_cbranch_scc1 Lt1_54
    buffer_store_dwordx2 v[8:9], v4, s[32:35], s60 offen sc1
    s_branch Lkvd_55
Lt1_54:
    s_mov_b32 exec_lo, 1048592
    s_mov_b32 exec_hi, 1048592
    v_mov_b32 v8, 0x3f803f80
    v_mov_b32 v9, 0x3f803f80
    s_mov_b32 exec_lo, 0x001f001f
    s_mov_b32 exec_hi, 0x001f001f
    buffer_store_dwordx2 v[8:9], v4, s[32:35], s60 offen offset:256 sc1
Lkvd_55:
    s_mov_b64 exec, -1
    s_barrier
    s_branch Lj_51
Lnokv_50:
    s_barrier
    s_barrier
    s_barrier
Lj_51:
    v_mov_b32 v9, 158720
    ds_read_b32 v9, v9
    s_waitcnt lgkmcnt(0)
    v_readfirstlane_b32 s66, v9
    s_cmp_ge_u32 s64, 4
    s_cbranch_scc1 Lnokvf_56
    s_cmp_ge_u32 s22, 4
    s_cbranch_scc1 Lnokvf_56
    v_mov_b32 v9, 158724
    v_mov_b32 v10, 1
    s_mov_b64 exec, 1
    s_waitcnt vmcnt(0)
    ds_add_rtn_u32 v10, v9, v10
    s_lshl_b32 s68, s65, 2
    s_add_u32 s68, s68, s64
    s_waitcnt lgkmcnt(0)
    v_readfirstlane_b32 s60, v10
    s_mov_b64 exec, -1
    s_cmp_lg_u32 s60, 3
    s_cbranch_scc1 Lnokvf_56
    s_lshl_b32 s60, s68, 2
    s_add_u32 s60, s60, 14221312
    v_lshlrev_b32 v9, 12, v1
    v_mov_b32 v10, s66
    s_mov_b64 exec, 255
    buffer_store_dword v10, v9, s[32:35], s60 offen sc1
    s_mov_b64 exec, -1
Lnokvf_56:
    s_barrier
    ds_read_b128 v[84:87], v12 offset:0
    ds_read_b64_tr_b16 v[88:89], v28 offset:35840
    ds_read_b64_tr_b16 v[90:91], v28 offset:36000
    ds_read_b128 v[92:95], v13 offset:0
    ds_read_b64_tr_b16 v[96:97], v28 offset:38400
    ds_read_b64_tr_b16 v[98:99], v28 offset:38560
    ds_read_b128 v[100:103], v14 offset:0
    ds_read_b64_tr_b16 v[104:105], v28 offset:40960
    ds_read_b64_tr_b16 v[106:107], v28 offset:41120
    s_waitcnt lgkmcnt(6)
    v_mfma_f32_32x32x16_bf16 v[36:51], v[88:91], v[84:87], 0
    ds_read_b128 v[108:111], v15 offset:0
    ds_read_b64_tr_b16 v[112:113], v28 offset:43520
    ds_read_b64_tr_b16 v[114:115], v28 offset:43680
    ds_read_b128 v[84:87], v12 offset:16384
    s_waitcnt lgkmcnt(7)
    v_mfma_f32_32x32x16_bf16 v[36:51], v[96:99], v[92:95], v[36:51]
    ds_read_b128 v[116:119], v16 offset:0
    ds_read_b64_tr_b16 v[120:121], v28 offset:46080
    ds_read_b64_tr_b16 v[122:123], v28 offset:46240
    ds_read_b128 v[92:95], v13 offset:16384
    s_waitcnt lgkmcnt(8)
    v_mfma_f32_32x32x16_bf16 v[36:51], v[104:107], v[100:103], v[36:51]
    ds_read_b128 v[124:127], v17 offset:0
    ds_read_b64_tr_b16 v[128:129], v28 offset:48640
    ds_read_b64_tr_b16 v[130:131], v28 offset:48800
    ds_read_b128 v[100:103], v14 offset:16384
    s_waitcnt lgkmcnt(9)
    v_mfma_f32_32x32x16_bf16 v[36:51], v[112:115], v[108:111], v[36:51]
    ds_read_b128 v[132:135], v18 offset:0
    ds_read_b64_tr_b16 v[136:137], v28 offset:51200
    ds_read_b64_tr_b16 v[138:139], v28 offset:51360
    ds_read_b128 v[108:111], v15 offset:16384
    s_waitcnt lgkmcnt(9)
    v_mfma_f32_32x32x16_bf16 v[36:51], v[120:123], v[116:119], v[36:51]
    ds_read_b128 v[140:143], v19 offset:0
    ds_read_b64_tr_b16 v[144:145], v28 offset:53760
    ds_read_b64_tr_b16 v[146:147], v28 offset:53920
    ds_read_b128 v[116:119], v16 offset:16384
    s_waitcnt lgkmcnt(9)
    v_mfma_f32_32x32x16_bf16 v[36:51], v[128:131], v[124:127], v[36:51]
    ds_read_b128 v[124:127], v17 offset:16384
    s_waitcnt lgkmcnt(6)
    v_mfma_f32_32x32x16_bf16 v[36:51], v[136:139], v[132:135], v[36:51]
    ds_read_b128 v[132:135], v18 offset:16384
    s_waitcnt lgkmcnt(3)
    v_mfma_f32_32x32x16_bf16 v[36:51], v[144:147], v[140:143], v[36:51]
    ds_read_b128 v[140:143], v19 offset:16384
    s_waitcnt lgkmcnt(0)
    s_barrier
    ds_read_b64_tr_b16 v[88:89], v28 offset:25600
    ds_read_b64_tr_b16 v[90:91], v28 offset:25760
    ds_read_b64_tr_b16 v[96:97], v28 offset:28160
    ds_read_b64_tr_b16 v[98:99], v28 offset:28320
    ds_read_b64_tr_b16 v[104:105], v28 offset:30720
    ds_read_b64_tr_b16 v[106:107], v28 offset:30880
    s_waitcnt lgkmcnt(4)
    v_mfma_f32_32x32x16_bf16 v[36:51], v[88:91], v[84:87], v[36:51]
    ds_read_b64_tr_b16 v[112:113], v28 offset:33280
    ds_read_b64_tr_b16 v[114:115], v28 offset:33440
    ds_read_b128 v[84:87], v20 offset:0
    s_waitcnt lgkmcnt(5)
    v_mfma_f32_32x32x16_bf16 v[36:51], v[96:99], v[92:95], v[36:51]
    ds_read_b64_tr_b16 v[120:121], v29 offset:0
    ds_read_b64_tr_b16 v[122:123], v29 offset:160
    ds_read_b128 v[92:95], v21 offset:0
    s_waitcnt lgkmcnt(6)
    v_mfma_f32_32x32x16_bf16 v[36:51], v[104:107], v[100:103], v[36:51]
    ds_read_b64_tr_b16 v[128:129], v29 offset:2560
    ds_read_b64_tr_b16 v[130:131], v29 offset:2720
    ds_read_b128 v[100:103], v22 offset:0
    s_waitcnt lgkmcnt(7)
    v_mfma_f32_32x32x16_bf16 v[36:51], v[112:115], v[108:111], v[36:51]
    ds_read_b64_tr_b16 v[136:137], v29 offset:5120
    ds_read_b64_tr_b16 v[138:139], v29 offset:5280
    ds_read_b128 v[108:111], v23 offset:0
    s_waitcnt lgkmcnt(7)
    v_mfma_f32_32x32x16_bf16 v[36:51], v[120:123], v[116:119], v[36:51]
    ds_read_b64_tr_b16 v[144:145], v29 offset:7680
    ds_read_b64_tr_b16 v[146:147], v29 offset:7840
    ds_read_b128 v[116:119], v24 offset:0
    s_waitcnt lgkmcnt(7)
    v_mfma_f32_32x32x16_bf16 v[36:51], v[128:131], v[124:127], v[36:51]
    ds_read_b128 v[124:127], v25 offset:0
    s_waitcnt lgkmcnt(5)
    v_mfma_f32_32x32x16_bf16 v[36:51], v[136:139], v[132:135], v[36:51]
    ds_read_b128 v[132:135], v26 offset:0
    s_waitcnt lgkmcnt(3)
    v_mfma_f32_32x32x16_bf16 v[36:51], v[144:147], v[140:143], v[36:51]
    ds_read_b128 v[140:143], v27 offset:0
    s_waitcnt lgkmcnt(0)
    s_barrier
    ds_read_b64_tr_b16 v[88:89], v28 offset:0
    ds_read_b64_tr_b16 v[90:91], v28 offset:160
    ds_read_b64_tr_b16 v[96:97], v28 offset:2560
    ds_read_b64_tr_b16 v[98:99], v28 offset:2720
    ds_read_b64_tr_b16 v[104:105], v28 offset:5120
    ds_read_b64_tr_b16 v[106:107], v28 offset:5280
    s_waitcnt lgkmcnt(4)
    v_mfma_f32_32x32x16_bf16 v[36:51], v[88:91], v[84:87], v[36:51]
    ds_read_b64_tr_b16 v[112:113], v28 offset:7680
    ds_read_b64_tr_b16 v[114:115], v28 offset:7840
    ds_read_b128 v[84:87], v20 offset:26624
    s_waitcnt lgkmcnt(5)
    v_mfma_f32_32x32x16_bf16 v[36:51], v[96:99], v[92:95], v[36:51]
    ds_read_b64_tr_b16 v[120:121], v28 offset:10240
    ds_read_b64_tr_b16 v[122:123], v28 offset:10400
    ds_read_b128 v[92:95], v21 offset:26624
    s_waitcnt lgkmcnt(6)
    v_mfma_f32_32x32x16_bf16 v[36:51], v[104:107], v[100:103], v[36:51]
    ds_read_b64_tr_b16 v[128:129], v28 offset:12800
    ds_read_b64_tr_b16 v[130:131], v28 offset:12960
    ds_read_b128 v[100:103], v22 offset:26624
    s_waitcnt lgkmcnt(7)
    v_mfma_f32_32x32x16_bf16 v[36:51], v[112:115], v[108:111], v[36:51]
    ds_read_b64_tr_b16 v[136:137], v28 offset:15360
    ds_read_b64_tr_b16 v[138:139], v28 offset:15520
    ds_read_b128 v[108:111], v23 offset:26624
    s_waitcnt lgkmcnt(7)
    v_mfma_f32_32x32x16_bf16 v[36:51], v[120:123], v[116:119], v[36:51]
    ds_read_b64_tr_b16 v[144:145], v28 offset:17920
    ds_read_b64_tr_b16 v[146:147], v28 offset:18080
    ds_read_b128 v[116:119], v24 offset:26624
    s_waitcnt lgkmcnt(7)
    v_mfma_f32_32x32x16_bf16 v[36:51], v[128:131], v[124:127], v[36:51]
    ds_read_b128 v[124:127], v25 offset:26624
    s_waitcnt lgkmcnt(5)
    v_mfma_f32_32x32x16_bf16 v[36:51], v[136:139], v[132:135], v[36:51]
    ds_read_b128 v[132:135], v26 offset:26624
    s_waitcnt lgkmcnt(3)
    v_mfma_f32_32x32x16_bf16 v[36:51], v[144:147], v[140:143], v[36:51]
    ds_read_b128 v[140:143], v27 offset:26624
    v_mov_b32 v9, 158728
    s_mov_b32 s61, 0
    s_cmp_ge_u32 s61, 1
    s_cbranch_scc1 Lprogok_58
    s_mov_b32 s44, 400000
Lprog_57:
    ds_read_b32 v10, v9
    s_sub_u32 s44, s44, 1
    s_cbranch_scc1 Lprogok_58
    s_waitcnt lgkmcnt(0)
    v_readfirstlane_b32 s61, v10
    s_cmp_lt_u32 s61, 1
    s_cbranch_scc1 Lprog_57
Lprogok_58:
    ds_read_b64_tr_b16 v[88:89], v28 offset:35840
    ds_read_b64_tr_b16 v[90:91], v28 offset:36000
    ds_read_b64_tr_b16 v[96:97], v28 offset:38400
    ds_read_b64_tr_b16 v[98:99], v28 offset:38560
    ds_read_b64_tr_b16 v[104:105], v28 offset:40960
    ds_read_b64_tr_b16 v[106:107], v28 offset:41120
    s_waitcnt lgkmcnt(4)
    v_mfma_f32_32x32x16_bf16 v[36:51], v[88:91], v[84:87], v[36:51]
    ds_read_b64_tr_b16 v[112:113], v28 offset:43520
    ds_read_b64_tr_b16 v[114:115], v28 offset:43680
    ds_read_b128 v[84:87], v20 offset:43008
    s_waitcnt lgkmcnt(5)
    v_mfma_f32_32x32x16_bf16 v[36:51], v[96:99], v[92:95], v[36:51]
    s_cmp_ge_u32 s61, 2
    s_cbranch_scc1 Lprogok_60
    s_mov_b32 s44, 400000
Lprog_59:
    ds_read_b32 v10, v9
    s_sub_u32 s44, s44, 1
    s_cbranch_scc1 Lprogok_60
    s_waitcnt lgkmcnt(0)
    v_readfirstlane_b32 s61, v10
    s_cmp_lt_u32 s61, 2
    s_cbranch_scc1 Lprog_59
Lprogok_60:
    ds_read_b64_tr_b16 v[120:121], v28 offset:46080
    ds_read_b64_tr_b16 v[122:123], v28 offset:46240
    ds_read_b128 v[92:95], v21 offset:43008
    s_waitcnt lgkmcnt(6)
    v_mfma_f32_32x32x16_bf16 v[36:51], v[104:107], v[100:103], v[36:51]
    ds_read_b64_tr_b16 v[128:129], v28 offset:48640
    ds_read_b64_tr_b16 v[130:131], v28 offset:48800
    ds_read_b128 v[100:103], v22 offset:43008
    s_waitcnt lgkmcnt(7)
    v_mfma_f32_32x32x16_bf16 v[36:51], v[112:115], v[108:111], v[36:51]
    ds_read_b64_tr_b16 v[136:137], v28 offset:51200
    ds_read_b64_tr_b16 v[138:139], v28 offset:51360
    ds_read_b128 v[108:111], v23 offset:43008
    s_waitcnt lgkmcnt(7)
    v_mfma_f32_32x32x16_bf16 v[36:51], v[120:123], v[116:119], v[36:51]
    ds_read_b64_tr_b16 v[144:145], v28 offset:53760
    ds_read_b64_tr_b16 v[146:147], v28 offset:53920
    ds_read_b128 v[116:119], v24 offset:43008
    s_waitcnt lgkmcnt(7)
    v_mfma_f32_32x32x16_bf16 v[36:51], v[128:131], v[124:127], v[36:51]
    ds_read_b128 v[124:127], v25 offset:43008
    s_waitcnt lgkmcnt(5)
    v_mfma_f32_32x32x16_bf16 v[36:51], v[136:139], v[132:135], v[36:51]
    ds_read_b128 v[132:135], v26 offset:43008
    s_waitcnt lgkmcnt(3)
    v_mfma_f32_32x32x16_bf16 v[36:51], v[144:147], v[140:143], v[36:51]
    ds_read_b128 v[140:143], v27 offset:43008
    s_cmp_ge_u32 s61, 3
    s_cbranch_scc1 Lprogok_62
    s_mov_b32 s44, 400000
Lprog_61:
    ds_read_b32 v10, v9
    s_sub_u32 s44, s44, 1
    s_cbranch_scc1 Lprogok_62
    s_waitcnt lgkmcnt(0)
    v_readfirstlane_b32 s61, v10
    s_cmp_lt_u32 s61, 3
    s_cbranch_scc1 Lprog_61
Lprogok_62:
    ds_read_b64_tr_b16 v[88:89], v30 offset:0
    ds_read_b64_tr_b16 v[90:91], v30 offset:160
    ds_read_b64_tr_b16 v[96:97], v30 offset:2560
    ds_read_b64_tr_b16 v[98:99], v30 offset:2720
    ds_read_b64_tr_b16 v[104:105], v30 offset:5120
    ds_read_b64_tr_b16 v[106:107], v30 offset:5280
    s_waitcnt lgkmcnt(4)
    v_mfma_f32_32x32x16_bf16 v[36:51], v[88:91], v[84:87], v[36:51]
    ds_read_b64_tr_b16 v[112:113], v30 offset:7680
    ds_read_b64_tr_b16 v[114:115], v30 offset:7840
    s_waitcnt lgkmcnt(4)
    v_mfma_f32_32x32x16_bf16 v[36:51], v[96:99], v[92:95], v[36:51]
    s_cmp_ge_u32 s61, 4
    s_cbranch_scc1 Lprogok_64
    s_mov_b32 s44, 400000
Lprog_63:
    ds_read_b32 v10, v9
    s_sub_u32 s44, s44, 1
    s_cbranch_scc1 Lprogok_64
    s_waitcnt lgkmcnt(0)
    v_readfirstlane_b32 s61, v10
    s_cmp_lt_u32 s61, 4
    s_cbranch_scc1 Lprog_63
Lprogok_64:
    ds_read_b64_tr_b16 v[120:121], v30 offset:10240
    ds_read_b64_tr_b16 v[122:123], v30 offset:10400
    s_waitcnt lgkmcnt(4)
    v_mfma_f32_32x32x16_bf16 v[36:51], v[104:107], v[100:103], v[36:51]
    ds_read_b64_tr_b16 v[128:129], v30 offset:12800
    ds_read_b64_tr_b16 v[130:131], v30 offset:12960
    s_waitcnt lgkmcnt(4)
    v_mfma_f32_32x32x16_bf16 v[36:51], v[112:115], v[108:111], v[36:51]
    ds_read_b64_tr_b16 v[136:137], v30 offset:15360
    ds_read_b64_tr_b16 v[138:139], v30 offset:15520
    s_waitcnt lgkmcnt(4)
    v_mfma_f32_32x32x16_bf16 v[36:51], v[120:123], v[116:119], v[36:51]
    ds_read_b64_tr_b16 v[144:145], v30 offset:17920
    ds_read_b64_tr_b16 v[146:147], v30 offset:18080
    s_waitcnt lgkmcnt(4)
    v_mfma_f32_32x32x16_bf16 v[36:51], v[128:131], v[124:127], v[36:51]
    s_waitcnt lgkmcnt(2)
    v_mfma_f32_32x32x16_bf16 v[36:51], v[136:139], v[132:135], v[36:51]
    s_waitcnt lgkmcnt(0)
    v_mfma_f32_32x32x16_bf16 v[36:51], v[144:147], v[140:143], v[36:51]
    s_mov_b32 s60, 0x3ea52b5c
    v_and_b32 v3, 31, v1
    v_lshlrev_b32 v3, 4, v3
    v_lshrrev_b32 v2, 5, v1
    v_mul_u32_u24 v2, 33920, v2
    v_add_u32 v2, v2, v3
    s_nop 6
    v_mul_f32 v36, s60, v36
    v_mul_f32 v37, s60, v37
    v_mul_f32 v38, s60, v38
    v_mul_f32 v39, s60, v39
    v_mul_f32 v40, s60, v40
    v_mul_f32 v41, s60, v41
    v_mul_f32 v42, s60, v42
    v_mul_f32 v43, s60, v43
    v_cvt_pk_bf16_f32 v16, v36, v37
    v_cvt_pk_bf16_f32 v17, v38, v39
    v_cvt_pk_bf16_f32 v18, v40, v41
    v_cvt_pk_bf16_f32 v19, v42, v43
    ds_write_b128 v31, v[16:19]
    v_mul_f32 v44, s60, v44
    v_mul_f32 v45, s60, v45
    v_mul_f32 v46, s60, v46
    v_mul_f32 v47, s60, v47
    v_cvt_pk_bf16_f32 v20, v44, v45
    v_cvt_pk_bf16_f32 v21, v46, v47
    ds_write_b64 v32, v[20:21] offset:1024
    s_waitcnt vmcnt(0) lgkmcnt(0)
    s_barrier
    ds_read_b128 v[12:15], v163
    ds_read_b64 v[20:21], v159 offset:1024
    ds_read_b64 v[22:23], v161 offset:2048
    ds_read_b128 v[24:27], v160 offset:0
    s_waitcnt lgkmcnt(1)
    v_mfma_f32_32x32x4bf16_1k v[84:115], v[22:23], v[20:21], 0 cbsz:1 abid:0
    s_waitcnt lgkmcnt(0)
    s_nop 15
    s_nop 0
    v_mfma_f32_32x32x16_bf16 v[84:99], v[24:27], v[12:15], v[84:99]
    v_mfma_f32_32x32x16_bf16 v[100:115], v[24:27], v[16:19], v[100:115]
    ds_read_b128 v[24:27], v160 offset:1024
    ds_read_b128 v[28:31], v162 offset:2112
    s_nop 5
    v_mfma_f32_32x32x4bf16_1k v[116:147], v[22:23], v[20:21], 0 cbsz:1 abid:1
    ds_read_b64 v[22:23], v161 offset:4608
    s_setprio 1
    v_exp_f32 v84, v84
    v_exp_f32 v85, v85
    v_exp_f32 v86, v86
    v_exp_f32 v87, v87
    v_cvt_pk_bf16_f32 v36, v84, v85
    v_cvt_pk_bf16_f32 v37, v86, v87
    v_exp_f32 v88, v88
    v_exp_f32 v89, v89
    v_exp_f32 v90, v90
    v_exp_f32 v91, v91
    v_cvt_pk_bf16_f32 v38, v88, v89
    v_cvt_pk_bf16_f32 v39, v90, v91
    ds_read_b128 v[32:35], v162 offset:2816
    v_exp_f32 v92, v92
    v_exp_f32 v93, v93
    v_exp_f32 v94, v94
    v_exp_f32 v95, v95
    v_cvt_pk_bf16_f32 v40, v92, v93
    v_cvt_pk_bf16_f32 v41, v94, v95
    s_waitcnt lgkmcnt(2)
    v_mfma_f32_32x32x16_bf16 v[116:131], v[24:27], v[12:15], v[116:131]
    v_exp_f32 v96, v96
    v_exp_f32 v97, v97
    v_exp_f32 v98, v98
    v_exp_f32 v99, v99
    v_cvt_pk_bf16_f32 v42, v96, v97
    v_cvt_pk_bf16_f32 v43, v98, v99
    v_mfma_f32_32x32x16_bf16 v[52:67], v[28:31], v[36:39], v[52:67]
    v_exp_f32 v100, v100
    v_exp_f32 v101, v101
    v_exp_f32 v102, v102
    v_exp_f32 v103, v103
    v_cvt_pk_bf16_f32 v44, v100, v101
    v_cvt_pk_bf16_f32 v45, v102, v103
    v_mfma_f32_32x32x16_bf16 v[132:147], v[24:27], v[16:19], v[132:147]
    ds_read_b128 v[24:27], v160 offset:2560
    v_exp_f32 v104, v104
    v_exp_f32 v105, v105
    v_exp_f32 v106, v106
    v_exp_f32 v107, v107
    v_cvt_pk_bf16_f32 v46, v104, v105
    v_cvt_pk_bf16_f32 v47, v106, v107
    s_waitcnt lgkmcnt(1)
    v_mfma_f32_32x32x16_bf16 v[52:67], v[32:35], v[40:43], v[52:67]
    v_exp_f32 v108, v108
    v_exp_f32 v109, v109
    v_exp_f32 v110, v110
    v_exp_f32 v111, v111
    v_cvt_pk_bf16_f32 v48, v108, v109
    v_cvt_pk_bf16_f32 v49, v110, v111
    v_mfma_f32_32x32x16_bf16 v[68:83], v[28:31], v[44:47], v[68:83]
    ds_read_b128 v[28:31], v162 offset:3520
    v_exp_f32 v112, v112
    v_exp_f32 v113, v113
    v_exp_f32 v114, v114
    v_exp_f32 v115, v115
    v_cvt_pk_bf16_f32 v50, v112, v113
    v_cvt_pk_bf16_f32 v51, v114, v115
    v_mfma_f32_32x32x4bf16_1k v[84:115], v[22:23], v[20:21], 0 cbsz:1 abid:0
    s_setprio 0
    v_exp_f32 v116, v116
    v_exp_f32 v117, v117
    v_exp_f32 v118, v118
    v_exp_f32 v119, v119
    v_cvt_pk_bf16_f32 v36, v116, v117
    v_cvt_pk_bf16_f32 v37, v118, v119
    v_exp_f32 v120, v120
    v_exp_f32 v121, v121
    v_exp_f32 v122, v122
    v_exp_f32 v123, v123
    v_cvt_pk_bf16_f32 v38, v120, v121
    v_cvt_pk_bf16_f32 v39, v122, v123
    v_mfma_f32_32x32x16_bf16 v[68:83], v[32:35], v[48:51], v[68:83]
    ds_read_b128 v[32:35], v162 offset:4224
    v_exp_f32 v124, v124
    v_exp_f32 v125, v125
    v_exp_f32 v126, v126
    v_exp_f32 v127, v127
    v_cvt_pk_bf16_f32 v40, v124, v125
    v_cvt_pk_bf16_f32 v41, v126, v127
    s_waitcnt lgkmcnt(1)
    v_mfma_f32_32x32x16_bf16 v[84:99], v[24:27], v[12:15], v[84:99]
    v_exp_f32 v128, v128
    v_exp_f32 v129, v129
    v_exp_f32 v130, v130
    v_exp_f32 v131, v131
    v_cvt_pk_bf16_f32 v42, v128, v129
    v_cvt_pk_bf16_f32 v43, v130, v131
    v_mfma_f32_32x32x16_bf16 v[52:67], v[28:31], v[36:39], v[52:67]
    v_exp_f32 v132, v132
    v_exp_f32 v133, v133
    v_exp_f32 v134, v134
    v_exp_f32 v135, v135
    v_cvt_pk_bf16_f32 v44, v132, v133
    v_cvt_pk_bf16_f32 v45, v134, v135
    v_mfma_f32_32x32x16_bf16 v[100:115], v[24:27], v[16:19], v[100:115]
    ds_read_b128 v[24:27], v160 offset:3584
    v_exp_f32 v136, v136
    v_exp_f32 v137, v137
    v_exp_f32 v138, v138
    v_exp_f32 v139, v139
    v_cvt_pk_bf16_f32 v46, v136, v137
    v_cvt_pk_bf16_f32 v47, v138, v139
    s_waitcnt lgkmcnt(1)
    v_mfma_f32_32x32x16_bf16 v[52:67], v[32:35], v[40:43], v[52:67]
    v_exp_f32 v140, v140
    v_exp_f32 v141, v141
    v_exp_f32 v142, v142
    v_exp_f32 v143, v143
    v_cvt_pk_bf16_f32 v48, v140, v141
    v_cvt_pk_bf16_f32 v49, v142, v143
    v_mfma_f32_32x32x16_bf16 v[68:83], v[28:31], v[44:47], v[68:83]
    ds_read_b128 v[28:31], v162 offset:4928
    v_exp_f32 v144, v144
    v_exp_f32 v145, v145
    v_exp_f32 v146, v146
    v_exp_f32 v147, v147
    v_cvt_pk_bf16_f32 v50, v144, v145
    v_cvt_pk_bf16_f32 v51, v146, v147
    s_waitcnt lgkmcnt(0)
    s_barrier
    v_mfma_f32_32x32x4bf16_1k v[116:147], v[22:23], v[20:21], 0 cbsz:1 abid:1
    ds_read_b64 v[22:23], v161 offset:23552
    s_setprio 3
    v_exp_f32 v84, v84
    v_exp_f32 v85, v85
    v_exp_f32 v86, v86
    v_exp_f32 v87, v87
    v_cvt_pk_bf16_f32 v36, v84, v85
    v_cvt_pk_bf16_f32 v37, v86, v87
    v_exp_f32 v88, v88
    v_exp_f32 v89, v89
    v_exp_f32 v90, v90
    v_exp_f32 v91, v91
    v_cvt_pk_bf16_f32 v38, v88, v89
    v_cvt_pk_bf16_f32 v39, v90, v91
    v_mfma_f32_32x32x16_bf16 v[68:83], v[32:35], v[48:51], v[68:83]
    ds_read_b128 v[32:35], v162 offset:21504
    v_exp_f32 v92, v92
    v_exp_f32 v93, v93
    v_exp_f32 v94, v94
    v_exp_f32 v95, v95
    v_cvt_pk_bf16_f32 v40, v92, v93
    v_cvt_pk_bf16_f32 v41, v94, v95
    s_waitcnt lgkmcnt(2)
    v_mfma_f32_32x32x16_bf16 v[116:131], v[24:27], v[12:15], v[116:131]
    v_exp_f32 v96, v96
    v_exp_f32 v97, v97
    v_exp_f32 v98, v98
    v_exp_f32 v99, v99
    v_cvt_pk_bf16_f32 v42, v96, v97
    v_cvt_pk_bf16_f32 v43, v98, v99
    v_mfma_f32_32x32x16_bf16 v[52:67], v[28:31], v[36:39], v[52:67]
    v_exp_f32 v100, v100
    v_exp_f32 v101, v101
    v_exp_f32 v102, v102
    v_exp_f32 v103, v103
    v_cvt_pk_bf16_f32 v44, v100, v101
    v_cvt_pk_bf16_f32 v45, v102, v103
    v_mfma_f32_32x32x16_bf16 v[132:147], v[24:27], v[16:19], v[132:147]
    ds_read_b128 v[24:27], v160 offset:21504
    v_exp_f32 v104, v104
    v_exp_f32 v105, v105
    v_exp_f32 v106, v106
    v_exp_f32 v107, v107
    v_cvt_pk_bf16_f32 v46, v104, v105
    v_cvt_pk_bf16_f32 v47, v106, v107
    s_waitcnt lgkmcnt(1)
    v_mfma_f32_32x32x16_bf16 v[52:67], v[32:35], v[40:43], v[52:67]
    v_exp_f32 v108, v108
    v_exp_f32 v109, v109
    v_exp_f32 v110, v110
    v_exp_f32 v111, v111
    v_cvt_pk_bf16_f32 v48, v108, v109
    v_cvt_pk_bf16_f32 v49, v110, v111
    v_mfma_f32_32x32x16_bf16 v[68:83], v[28:31], v[44:47], v[68:83]
    ds_read_b128 v[28:31], v162 offset:22208
    v_exp_f32 v112, v112
    v_exp_f32 v113, v113
    v_exp_f32 v114, v114
    v_exp_f32 v115, v115
    v_cvt_pk_bf16_f32 v50, v112, v113
    v_cvt_pk_bf16_f32 v51, v114, v115
    v_mfma_f32_32x32x4bf16_1k v[84:115], v[22:23], v[20:21], 0 cbsz:1 abid:0
    s_setprio 2
    v_exp_f32 v116, v116
    v_exp_f32 v117, v117
    v_exp_f32 v118, v118
    v_exp_f32 v119, v119
    v_cvt_pk_bf16_f32 v36, v116, v117
    v_cvt_pk_bf16_f32 v37, v118, v119
    v_exp_f32 v120, v120
    v_exp_f32 v121, v121
    v_exp_f32 v122, v122
    v_exp_f32 v123, v123
    v_cvt_pk_bf16_f32 v38, v120, v121
    v_cvt_pk_bf16_f32 v39, v122, v123
    v_mfma_f32_32x32x16_bf16 v[68:83], v[32:35], v[48:51], v[68:83]
    ds_read_b128 v[32:35], v162 offset:22912
    v_exp_f32 v124, v124
    v_exp_f32 v125, v125
    v_exp_f32 v126, v126
    v_exp_f32 v127, v127
    v_cvt_pk_bf16_f32 v40, v124, v125
    v_cvt_pk_bf16_f32 v41, v126, v127
    s_waitcnt lgkmcnt(1)
    v_mfma_f32_32x32x16_bf16 v[84:99], v[24:27], v[12:15], v[84:99]
    v_exp_f32 v128, v128
    v_exp_f32 v129, v129
    v_exp_f32 v130, v130
    v_exp_f32 v131, v131
    v_cvt_pk_bf16_f32 v42, v128, v129
    v_cvt_pk_bf16_f32 v43, v130, v131
    v_mfma_f32_32x32x16_bf16 v[52:67], v[28:31], v[36:39], v[52:67]
    v_exp_f32 v132, v132
    v_exp_f32 v133, v133
    v_exp_f32 v134, v134
    v_exp_f32 v135, v135
    v_cvt_pk_bf16_f32 v44, v132, v133
    v_cvt_pk_bf16_f32 v45, v134, v135
    v_mfma_f32_32x32x16_bf16 v[100:115], v[24:27], v[16:19], v[100:115]
    ds_read_b128 v[24:27], v160 offset:22528
    v_exp_f32 v136, v136
    v_exp_f32 v137, v137
    v_exp_f32 v138, v138
    v_exp_f32 v139, v139
    v_cvt_pk_bf16_f32 v46, v136, v137
    v_cvt_pk_bf16_f32 v47, v138, v139
    s_waitcnt lgkmcnt(1)
    v_mfma_f32_32x32x16_bf16 v[52:67], v[32:35], v[40:43], v[52:67]
    v_exp_f32 v140, v140
    v_exp_f32 v141, v141
    v_exp_f32 v142, v142
    v_exp_f32 v143, v143
    v_cvt_pk_bf16_f32 v48, v140, v141
    v_cvt_pk_bf16_f32 v49, v142, v143
    v_mfma_f32_32x32x16_bf16 v[68:83], v[28:31], v[44:47], v[68:83]
    ds_read_b128 v[28:31], v162 offset:23616
    v_exp_f32 v144, v144
    v_exp_f32 v145, v145
    v_exp_f32 v146, v146
    v_exp_f32 v147, v147
    v_cvt_pk_bf16_f32 v50, v144, v145
    v_cvt_pk_bf16_f32 v51, v146, v147
    v_mfma_f32_32x32x4bf16_1k v[116:147], v[22:23], v[20:21], 0 cbsz:1 abid:1
    ds_read_b64 v[22:23], v161 offset:26112
    s_setprio 1
    v_exp_f32 v84, v84
    v_exp_f32 v85, v85
    v_exp_f32 v86, v86
    v_exp_f32 v87, v87
    v_cvt_pk_bf16_f32 v36, v84, v85
    v_cvt_pk_bf16_f32 v37, v86, v87
    v_exp_f32 v88, v88
    v_exp_f32 v89, v89
    v_exp_f32 v90, v90
    v_exp_f32 v91, v91
    v_cvt_pk_bf16_f32 v38, v88, v89
    v_cvt_pk_bf16_f32 v39, v90, v91
    v_mfma_f32_32x32x16_bf16 v[68:83], v[32:35], v[48:51], v[68:83]
    ds_read_b128 v[32:35], v162 offset:24320
    v_exp_f32 v92, v92
    v_exp_f32 v93, v93
    v_exp_f32 v94, v94
    v_exp_f32 v95, v95
    v_cvt_pk_bf16_f32 v40, v92, v93
    v_cvt_pk_bf16_f32 v41, v94, v95
    s_waitcnt lgkmcnt(2)
    v_mfma_f32_32x32x16_bf16 v[116:131], v[24:27], v[12:15], v[116:131]
    v_exp_f32 v96, v96
    v_exp_f32 v97, v97
    v_exp_f32 v98, v98
    v_exp_f32 v99, v99
    v_cvt_pk_bf16_f32 v42, v96, v97
    v_cvt_pk_bf16_f32 v43, v98, v99
    v_mfma_f32_32x32x16_bf16 v[52:67], v[28:31], v[36:39], v[52:67]
    v_exp_f32 v100, v100
    v_exp_f32 v101, v101
    v_exp_f32 v102, v102
    v_exp_f32 v103, v103
    v_cvt_pk_bf16_f32 v44, v100, v101
    v_cvt_pk_bf16_f32 v45, v102, v103
    v_mfma_f32_32x32x16_bf16 v[132:147], v[24:27], v[16:19], v[132:147]
    ds_read_b128 v[24:27], v160 offset:24064
    v_exp_f32 v104, v104
    v_exp_f32 v105, v105
    v_exp_f32 v106, v106
    v_exp_f32 v107, v107
    v_cvt_pk_bf16_f32 v46, v104, v105
    v_cvt_pk_bf16_f32 v47, v106, v107
    s_waitcnt lgkmcnt(1)
    v_mfma_f32_32x32x16_bf16 v[52:67], v[32:35], v[40:43], v[52:67]
    v_exp_f32 v108, v108
    v_exp_f32 v109, v109
    v_exp_f32 v110, v110
    v_exp_f32 v111, v111
    v_cvt_pk_bf16_f32 v48, v108, v109
    v_cvt_pk_bf16_f32 v49, v110, v111
    v_mfma_f32_32x32x16_bf16 v[68:83], v[28:31], v[44:47], v[68:83]
    ds_read_b128 v[28:31], v162 offset:25024
    v_exp_f32 v112, v112
    v_exp_f32 v113, v113
    v_exp_f32 v114, v114
    v_exp_f32 v115, v115
    v_cvt_pk_bf16_f32 v50, v112, v113
    v_cvt_pk_bf16_f32 v51, v114, v115
    v_mfma_f32_32x32x4bf16_1k v[84:115], v[22:23], v[20:21], 0 cbsz:1 abid:0
    s_setprio 0
    v_exp_f32 v116, v116
    v_exp_f32 v117, v117
    v_exp_f32 v118, v118
    v_exp_f32 v119, v119
    v_cvt_pk_bf16_f32 v36, v116, v117
    v_cvt_pk_bf16_f32 v37, v118, v119
    v_exp_f32 v120, v120
    v_exp_f32 v121, v121
    v_exp_f32 v122, v122
    v_exp_f32 v123, v123
    v_cvt_pk_bf16_f32 v38, v120, v121
    v_cvt_pk_bf16_f32 v39, v122, v123
    v_mfma_f32_32x32x16_bf16 v[68:83], v[32:35], v[48:51], v[68:83]
    ds_read_b128 v[32:35], v162 offset:25728
    v_exp_f32 v124, v124
    v_exp_f32 v125, v125
    v_exp_f32 v126, v126
    v_exp_f32 v127, v127
    v_cvt_pk_bf16_f32 v40, v124, v125
    v_cvt_pk_bf16_f32 v41, v126, v127
    s_waitcnt lgkmcnt(1)
    v_mfma_f32_32x32x16_bf16 v[84:99], v[24:27], v[12:15], v[84:99]
    v_exp_f32 v128, v128
    v_exp_f32 v129, v129
    v_exp_f32 v130, v130
    v_exp_f32 v131, v131
    v_cvt_pk_bf16_f32 v42, v128, v129
    v_cvt_pk_bf16_f32 v43, v130, v131
    v_mfma_f32_32x32x16_bf16 v[52:67], v[28:31], v[36:39], v[52:67]
    v_exp_f32 v132, v132
    v_exp_f32 v133, v133
    v_exp_f32 v134, v134
    v_exp_f32 v135, v135
    v_cvt_pk_bf16_f32 v44, v132, v133
    v_cvt_pk_bf16_f32 v45, v134, v135
    v_mfma_f32_32x32x16_bf16 v[100:115], v[24:27], v[16:19], v[100:115]
    ds_read_b128 v[24:27], v160 offset:25088
    v_exp_f32 v136, v136
    v_exp_f32 v137, v137
    v_exp_f32 v138, v138
    v_exp_f32 v139, v139
    v_cvt_pk_bf16_f32 v46, v136, v137
    v_cvt_pk_bf16_f32 v47, v138, v139
    s_waitcnt lgkmcnt(1)
    v_mfma_f32_32x32x16_bf16 v[52:67], v[32:35], v[40:43], v[52:67]
    v_exp_f32 v140, v140
    v_exp_f32 v141, v141
    v_exp_f32 v142, v142
    v_exp_f32 v143, v143
    v_cvt_pk_bf16_f32 v48, v140, v141
    v_cvt_pk_bf16_f32 v49, v142, v143
    v_mfma_f32_32x32x16_bf16 v[68:83], v[28:31], v[44:47], v[68:83]
    ds_read_b128 v[28:31], v162 offset:26432
    v_exp_f32 v144, v144
    v_exp_f32 v145, v145
    v_exp_f32 v146, v146
    v_exp_f32 v147, v147
    v_cvt_pk_bf16_f32 v50, v144, v145
    v_cvt_pk_bf16_f32 v51, v146, v147
    s_waitcnt lgkmcnt(0)
    s_barrier
    v_mfma_f32_32x32x4bf16_1k v[116:147], v[22:23], v[20:21], 0 cbsz:1 abid:1
    ds_read_b64 v[22:23], v161 offset:45056
    s_setprio 3
    v_exp_f32 v84, v84
    v_exp_f32 v85, v85
    v_exp_f32 v86, v86
    v_exp_f32 v87, v87
    v_cvt_pk_bf16_f32 v36, v84, v85
    v_cvt_pk_bf16_f32 v37, v86, v87
    v_exp_f32 v88, v88
    v_exp_f32 v89, v89
    v_exp_f32 v90, v90
    v_exp_f32 v91, v91
    v_cvt_pk_bf16_f32 v38, v88, v89
    v_cvt_pk_bf16_f32 v39, v90, v91
    v_mfma_f32_32x32x16_bf16 v[68:83], v[32:35], v[48:51], v[68:83]
    ds_read_b128 v[32:35], v162 offset:43008
    v_exp_f32 v92, v92
    v_exp_f32 v93, v93
    v_exp_f32 v94, v94
    v_exp_f32 v95, v95
    v_cvt_pk_bf16_f32 v40, v92, v93
    v_cvt_pk_bf16_f32 v41, v94, v95
    s_waitcnt lgkmcnt(2)
    v_mfma_f32_32x32x16_bf16 v[116:131], v[24:27], v[12:15], v[116:131]
    v_exp_f32 v96, v96
    v_exp_f32 v97, v97
    v_exp_f32 v98, v98
    v_exp_f32 v99, v99
    v_cvt_pk_bf16_f32 v42, v96, v97
    v_cvt_pk_bf16_f32 v43, v98, v99
    v_mfma_f32_32x32x16_bf16 v[52:67], v[28:31], v[36:39], v[52:67]
    v_exp_f32 v100, v100
    v_exp_f32 v101, v101
    v_exp_f32 v102, v102
    v_exp_f32 v103, v103
    v_cvt_pk_bf16_f32 v44, v100, v101
    v_cvt_pk_bf16_f32 v45, v102, v103
    v_mfma_f32_32x32x16_bf16 v[132:147], v[24:27], v[16:19], v[132:147]
    ds_read_b128 v[24:27], v160 offset:43008
    v_exp_f32 v104, v104
    v_exp_f32 v105, v105
    v_exp_f32 v106, v106
    v_exp_f32 v107, v107
    v_cvt_pk_bf16_f32 v46, v104, v105
    v_cvt_pk_bf16_f32 v47, v106, v107
    s_waitcnt lgkmcnt(1)
    v_mfma_f32_32x32x16_bf16 v[52:67], v[32:35], v[40:43], v[52:67]
    v_exp_f32 v108, v108
    v_exp_f32 v109, v109
    v_exp_f32 v110, v110
    v_exp_f32 v111, v111
    v_cvt_pk_bf16_f32 v48, v108, v109
    v_cvt_pk_bf16_f32 v49, v110, v111
    v_mfma_f32_32x32x16_bf16 v[68:83], v[28:31], v[44:47], v[68:83]
    ds_read_b128 v[28:31], v162 offset:43712
    v_exp_f32 v112, v112
    v_exp_f32 v113, v113
    v_exp_f32 v114, v114
    v_exp_f32 v115, v115
    v_cvt_pk_bf16_f32 v50, v112, v113
    v_cvt_pk_bf16_f32 v51, v114, v115
    v_mfma_f32_32x32x4bf16_1k v[84:115], v[22:23], v[20:21], 0 cbsz:1 abid:0
    s_setprio 2
    v_exp_f32 v116, v116
    v_exp_f32 v117, v117
    v_exp_f32 v118, v118
    v_exp_f32 v119, v119
    v_cvt_pk_bf16_f32 v36, v116, v117
    v_cvt_pk_bf16_f32 v37, v118, v119
    v_exp_f32 v120, v120
    v_exp_f32 v121, v121
    v_exp_f32 v122, v122
    v_exp_f32 v123, v123
    v_cvt_pk_bf16_f32 v38, v120, v121
    v_cvt_pk_bf16_f32 v39, v122, v123
    v_mfma_f32_32x32x16_bf16 v[68:83], v[32:35], v[48:51], v[68:83]
    ds_read_b128 v[32:35], v162 offset:44416
    v_exp_f32 v124, v124
    v_exp_f32 v125, v125
    v_exp_f32 v126, v126
    v_exp_f32 v127, v127
    v_cvt_pk_bf16_f32 v40, v124, v125
    v_cvt_pk_bf16_f32 v41, v126, v127
    s_waitcnt lgkmcnt(1)
    v_mfma_f32_32x32x16_bf16 v[84:99], v[24:27], v[12:15], v[84:99]
    v_exp_f32 v128, v128
    v_exp_f32 v129, v129
    v_exp_f32 v130, v130
    v_exp_f32 v131, v131
    v_cvt_pk_bf16_f32 v42, v128, v129
    v_cvt_pk_bf16_f32 v43, v130, v131
    v_mfma_f32_32x32x16_bf16 v[52:67], v[28:31], v[36:39], v[52:67]
    v_exp_f32 v132, v132
    v_exp_f32 v133, v133
    v_exp_f32 v134, v134
    v_exp_f32 v135, v135
    v_cvt_pk_bf16_f32 v44, v132, v133
    v_cvt_pk_bf16_f32 v45, v134, v135
    v_mfma_f32_32x32x16_bf16 v[100:115], v[24:27], v[16:19], v[100:115]
    ds_read_b128 v[24:27], v160 offset:44032
    v_exp_f32 v136, v136
    v_exp_f32 v137, v137
    v_exp_f32 v138, v138
    v_exp_f32 v139, v139
    v_cvt_pk_bf16_f32 v46, v136, v137
    v_cvt_pk_bf16_f32 v47, v138, v139
    s_waitcnt lgkmcnt(1)
    v_mfma_f32_32x32x16_bf16 v[52:67], v[32:35], v[40:43], v[52:67]
    v_exp_f32 v140, v140
    v_exp_f32 v141, v141
    v_exp_f32 v142, v142
    v_exp_f32 v143, v143
    v_cvt_pk_bf16_f32 v48, v140, v141
    v_cvt_pk_bf16_f32 v49, v142, v143
    v_mfma_f32_32x32x16_bf16 v[68:83], v[28:31], v[44:47], v[68:83]
    ds_read_b128 v[28:31], v162 offset:45120
    v_exp_f32 v144, v144
    v_exp_f32 v145, v145
    v_exp_f32 v146, v146
    v_exp_f32 v147, v147
    v_cvt_pk_bf16_f32 v50, v144, v145
    v_cvt_pk_bf16_f32 v51, v146, v147
    v_mfma_f32_32x32x4bf16_1k v[116:147], v[22:23], v[20:21], 0 cbsz:1 abid:1
    ds_read_b64 v[22:23], v161 offset:47616
    s_setprio 1
    v_exp_f32 v84, v84
    v_exp_f32 v85, v85
    v_exp_f32 v86, v86
    v_exp_f32 v87, v87
    v_cvt_pk_bf16_f32 v36, v84, v85
    v_cvt_pk_bf16_f32 v37, v86, v87
    v_exp_f32 v88, v88
    v_exp_f32 v89, v89
    v_exp_f32 v90, v90
    v_exp_f32 v91, v91
    v_cvt_pk_bf16_f32 v38, v88, v89
    v_cvt_pk_bf16_f32 v39, v90, v91
    v_mfma_f32_32x32x16_bf16 v[68:83], v[32:35], v[48:51], v[68:83]
    ds_read_b128 v[32:35], v162 offset:45824
    v_exp_f32 v92, v92
    v_exp_f32 v93, v93
    v_exp_f32 v94, v94
    v_exp_f32 v95, v95
    v_cvt_pk_bf16_f32 v40, v92, v93
    v_cvt_pk_bf16_f32 v41, v94, v95
    s_waitcnt lgkmcnt(2)
    v_mfma_f32_32x32x16_bf16 v[116:131], v[24:27], v[12:15], v[116:131]
    v_exp_f32 v96, v96
    v_exp_f32 v97, v97
    v_exp_f32 v98, v98
    v_exp_f32 v99, v99
    v_cvt_pk_bf16_f32 v42, v96, v97
    v_cvt_pk_bf16_f32 v43, v98, v99
    v_mfma_f32_32x32x16_bf16 v[52:67], v[28:31], v[36:39], v[52:67]
    v_exp_f32 v100, v100
    v_exp_f32 v101, v101
    v_exp_f32 v102, v102
    v_exp_f32 v103, v103
    v_cvt_pk_bf16_f32 v44, v100, v101
    v_cvt_pk_bf16_f32 v45, v102, v103
    v_mfma_f32_32x32x16_bf16 v[132:147], v[24:27], v[16:19], v[132:147]
    ds_read_b128 v[24:27], v160 offset:45568
    v_exp_f32 v104, v104
    v_exp_f32 v105, v105
    v_exp_f32 v106, v106
    v_exp_f32 v107, v107
    v_cvt_pk_bf16_f32 v46, v104, v105
    v_cvt_pk_bf16_f32 v47, v106, v107
    s_waitcnt lgkmcnt(1)
    v_mfma_f32_32x32x16_bf16 v[52:67], v[32:35], v[40:43], v[52:67]
    v_exp_f32 v108, v108
    v_exp_f32 v109, v109
    v_exp_f32 v110, v110
    v_exp_f32 v111, v111
    v_cvt_pk_bf16_f32 v48, v108, v109
    v_cvt_pk_bf16_f32 v49, v110, v111
    v_mfma_f32_32x32x16_bf16 v[68:83], v[28:31], v[44:47], v[68:83]
    ds_read_b128 v[28:31], v162 offset:46528
    v_exp_f32 v112, v112
    v_exp_f32 v113, v113
    v_exp_f32 v114, v114
    v_exp_f32 v115, v115
    v_cvt_pk_bf16_f32 v50, v112, v113
    v_cvt_pk_bf16_f32 v51, v114, v115
    v_mfma_f32_32x32x4bf16_1k v[84:115], v[22:23], v[20:21], 0 cbsz:1 abid:0
    s_setprio 0
    v_exp_f32 v116, v116
    v_exp_f32 v117, v117
    v_exp_f32 v118, v118
    v_exp_f32 v119, v119
    v_cvt_pk_bf16_f32 v36, v116, v117
    v_cvt_pk_bf16_f32 v37, v118, v119
    v_exp_f32 v120, v120
    v_exp_f32 v121, v121
    v_exp_f32 v122, v122
    v_exp_f32 v123, v123
    v_cvt_pk_bf16_f32 v38, v120, v121
    v_cvt_pk_bf16_f32 v39, v122, v123
    v_mfma_f32_32x32x16_bf16 v[68:83], v[32:35], v[48:51], v[68:83]
    ds_read_b128 v[32:35], v162 offset:47232
    v_exp_f32 v124, v124
    v_exp_f32 v125, v125
    v_exp_f32 v126, v126
    v_exp_f32 v127, v127
    v_cvt_pk_bf16_f32 v40, v124, v125
    v_cvt_pk_bf16_f32 v41, v126, v127
    s_waitcnt lgkmcnt(1)
    v_mfma_f32_32x32x16_bf16 v[84:99], v[24:27], v[12:15], v[84:99]
    v_exp_f32 v128, v128
    v_exp_f32 v129, v129
    v_exp_f32 v130, v130
    v_exp_f32 v131, v131
    v_cvt_pk_bf16_f32 v42, v128, v129
    v_cvt_pk_bf16_f32 v43, v130, v131
    v_mfma_f32_32x32x16_bf16 v[52:67], v[28:31], v[36:39], v[52:67]
    v_exp_f32 v132, v132
    v_exp_f32 v133, v133
    v_exp_f32 v134, v134
    v_exp_f32 v135, v135
    v_cvt_pk_bf16_f32 v44, v132, v133
    v_cvt_pk_bf16_f32 v45, v134, v135
    v_mfma_f32_32x32x16_bf16 v[100:115], v[24:27], v[16:19], v[100:115]
    ds_read_b128 v[24:27], v160 offset:46592
    v_exp_f32 v136, v136
    v_exp_f32 v137, v137
    v_exp_f32 v138, v138
    v_exp_f32 v139, v139
    v_cvt_pk_bf16_f32 v46, v136, v137
    v_cvt_pk_bf16_f32 v47, v138, v139
    s_waitcnt lgkmcnt(1)
    v_mfma_f32_32x32x16_bf16 v[52:67], v[32:35], v[40:43], v[52:67]
    v_exp_f32 v140, v140
    v_exp_f32 v141, v141
    v_exp_f32 v142, v142
    v_exp_f32 v143, v143
    v_cvt_pk_bf16_f32 v48, v140, v141
    v_cvt_pk_bf16_f32 v49, v142, v143
    v_mfma_f32_32x32x16_bf16 v[68:83], v[28:31], v[44:47], v[68:83]
    ds_read_b128 v[28:31], v162 offset:47936
    v_exp_f32 v144, v144
    v_exp_f32 v145, v145
    v_exp_f32 v146, v146
    v_exp_f32 v147, v147
    v_cvt_pk_bf16_f32 v50, v144, v145
    v_cvt_pk_bf16_f32 v51, v146, v147
    s_waitcnt lgkmcnt(0)
    s_barrier
    v_mfma_f32_32x32x4bf16_1k v[116:147], v[22:23], v[20:21], 0 cbsz:1 abid:1
    ds_read_b64 v[22:23], v161 offset:2048
    s_setprio 3
    v_exp_f32 v84, v84
    v_exp_f32 v85, v85
    v_exp_f32 v86, v86
    v_exp_f32 v87, v87
    v_cvt_pk_bf16_f32 v36, v84, v85
    v_cvt_pk_bf16_f32 v37, v86, v87
    v_exp_f32 v88, v88
    v_exp_f32 v89, v89
    v_exp_f32 v90, v90
    v_exp_f32 v91, v91
    v_cvt_pk_bf16_f32 v38, v88, v89
    v_cvt_pk_bf16_f32 v39, v90, v91
    v_mfma_f32_32x32x16_bf16 v[68:83], v[32:35], v[48:51], v[68:83]
    ds_read_b128 v[32:35], v162 offset:0
    v_exp_f32 v92, v92
    v_exp_f32 v93, v93
    v_exp_f32 v94, v94
    v_exp_f32 v95, v95
    v_cvt_pk_bf16_f32 v40, v92, v93
    v_cvt_pk_bf16_f32 v41, v94, v95
    s_waitcnt lgkmcnt(2)
    v_mfma_f32_32x32x16_bf16 v[116:131], v[24:27], v[12:15], v[116:131]
    v_exp_f32 v96, v96
    v_exp_f32 v97, v97
    v_exp_f32 v98, v98
    v_exp_f32 v99, v99
    v_cvt_pk_bf16_f32 v42, v96, v97
    v_cvt_pk_bf16_f32 v43, v98, v99
    v_mfma_f32_32x32x16_bf16 v[52:67], v[28:31], v[36:39], v[52:67]
    v_exp_f32 v100, v100
    v_exp_f32 v101, v101
    v_exp_f32 v102, v102
    v_exp_f32 v103, v103
    v_cvt_pk_bf16_f32 v44, v100, v101
    v_cvt_pk_bf16_f32 v45, v102, v103
    v_mfma_f32_32x32x16_bf16 v[132:147], v[24:27], v[16:19], v[132:147]
    ds_read_b128 v[24:27], v160 offset:0
    v_exp_f32 v104, v104
    v_exp_f32 v105, v105
    v_exp_f32 v106, v106
    v_exp_f32 v107, v107
    v_cvt_pk_bf16_f32 v46, v104, v105
    v_cvt_pk_bf16_f32 v47, v106, v107
    s_waitcnt lgkmcnt(1)
    v_mfma_f32_32x32x16_bf16 v[52:67], v[32:35], v[40:43], v[52:67]
    v_exp_f32 v108, v108
    v_exp_f32 v109, v109
    v_exp_f32 v110, v110
    v_exp_f32 v111, v111
    v_cvt_pk_bf16_f32 v48, v108, v109
    v_cvt_pk_bf16_f32 v49, v110, v111
    v_mfma_f32_32x32x16_bf16 v[68:83], v[28:31], v[44:47], v[68:83]
    ds_read_b128 v[28:31], v162 offset:704
    v_exp_f32 v112, v112
    v_exp_f32 v113, v113
    v_exp_f32 v114, v114
    v_exp_f32 v115, v115
    v_cvt_pk_bf16_f32 v50, v112, v113
    v_cvt_pk_bf16_f32 v51, v114, v115
    v_mfma_f32_32x32x4bf16_1k v[84:115], v[22:23], v[20:21], 0 cbsz:1 abid:0
    s_setprio 2
    v_exp_f32 v116, v116
    v_exp_f32 v117, v117
    v_exp_f32 v118, v118
    v_exp_f32 v119, v119
    v_cvt_pk_bf16_f32 v36, v116, v117
    v_cvt_pk_bf16_f32 v37, v118, v119
    v_exp_f32 v120, v120
    v_exp_f32 v121, v121
    v_exp_f32 v122, v122
    v_exp_f32 v123, v123
    v_cvt_pk_bf16_f32 v38, v120, v121
    v_cvt_pk_bf16_f32 v39, v122, v123
    v_mfma_f32_32x32x16_bf16 v[68:83], v[32:35], v[48:51], v[68:83]
    ds_read_b128 v[32:35], v162 offset:1408
    v_exp_f32 v124, v124
    v_exp_f32 v125, v125
    v_exp_f32 v126, v126
    v_exp_f32 v127, v127
    v_cvt_pk_bf16_f32 v40, v124, v125
    v_cvt_pk_bf16_f32 v41, v126, v127
    s_waitcnt lgkmcnt(1)
    v_mfma_f32_32x32x16_bf16 v[84:99], v[24:27], v[12:15], v[84:99]
    v_exp_f32 v128, v128
    v_exp_f32 v129, v129
    v_exp_f32 v130, v130
    v_exp_f32 v131, v131
    v_cvt_pk_bf16_f32 v42, v128, v129
    v_cvt_pk_bf16_f32 v43, v130, v131
    v_mfma_f32_32x32x16_bf16 v[52:67], v[28:31], v[36:39], v[52:67]
    v_exp_f32 v132, v132
    v_exp_f32 v133, v133
    v_exp_f32 v134, v134
    v_exp_f32 v135, v135
    v_cvt_pk_bf16_f32 v44, v132, v133
    v_cvt_pk_bf16_f32 v45, v134, v135
    v_mfma_f32_32x32x16_bf16 v[100:115], v[24:27], v[16:19], v[100:115]
    ds_read_b128 v[24:27], v160 offset:1024
    v_exp_f32 v136, v136
    v_exp_f32 v137, v137
    v_exp_f32 v138, v138
    v_exp_f32 v139, v139
    v_cvt_pk_bf16_f32 v46, v136, v137
    v_cvt_pk_bf16_f32 v47, v138, v139
    s_waitcnt lgkmcnt(1)
    v_mfma_f32_32x32x16_bf16 v[52:67], v[32:35], v[40:43], v[52:67]
    v_exp_f32 v140, v140
    v_exp_f32 v141, v141
    v_exp_f32 v142, v142
    v_exp_f32 v143, v143
    v_cvt_pk_bf16_f32 v48, v140, v141
    v_cvt_pk_bf16_f32 v49, v142, v143
    v_mfma_f32_32x32x16_bf16 v[68:83], v[28:31], v[44:47], v[68:83]
    ds_read_b128 v[28:31], v162 offset:2112
    v_exp_f32 v144, v144
    v_exp_f32 v145, v145
    v_exp_f32 v146, v146
    v_exp_f32 v147, v147
    v_cvt_pk_bf16_f32 v50, v144, v145
    v_cvt_pk_bf16_f32 v51, v146, v147
    v_mfma_f32_32x32x4bf16_1k v[116:147], v[22:23], v[20:21], 0 cbsz:1 abid:1
    ds_read_b64 v[22:23], v161 offset:4608
    s_setprio 1
    v_exp_f32 v84, v84
    v_exp_f32 v85, v85
    v_exp_f32 v86, v86
    v_exp_f32 v87, v87
    v_cvt_pk_bf16_f32 v36, v84, v85
    v_cvt_pk_bf16_f32 v37, v86, v87
    v_exp_f32 v88, v88
    v_exp_f32 v89, v89
    v_exp_f32 v90, v90
    v_exp_f32 v91, v91
    v_cvt_pk_bf16_f32 v38, v88, v89
    v_cvt_pk_bf16_f32 v39, v90, v91
    v_mfma_f32_32x32x16_bf16 v[68:83], v[32:35], v[48:51], v[68:83]
    ds_read_b128 v[32:35], v162 offset:2816
    v_exp_f32 v92, v92
    v_exp_f32 v93, v93
    v_exp_f32 v94, v94
    v_exp_f32 v95, v95
    v_cvt_pk_bf16_f32 v40, v92, v93
    v_cvt_pk_bf16_f32 v41, v94, v95
    s_waitcnt lgkmcnt(2)
    v_mfma_f32_32x32x16_bf16 v[116:131], v[24:27], v[12:15], v[116:131]
    v_exp_f32 v96, v96
    v_exp_f32 v97, v97
    v_exp_f32 v98, v98
    v_exp_f32 v99, v99
    v_cvt_pk_bf16_f32 v42, v96, v97
    v_cvt_pk_bf16_f32 v43, v98, v99
    v_mfma_f32_32x32x16_bf16 v[52:67], v[28:31], v[36:39], v[52:67]
    v_exp_f32 v100, v100
    v_exp_f32 v101, v101
    v_exp_f32 v102, v102
    v_exp_f32 v103, v103
    v_cvt_pk_bf16_f32 v44, v100, v101
    v_cvt_pk_bf16_f32 v45, v102, v103
    v_mfma_f32_32x32x16_bf16 v[132:147], v[24:27], v[16:19], v[132:147]
    ds_read_b128 v[24:27], v160 offset:2560
    v_exp_f32 v104, v104
    v_exp_f32 v105, v105
    v_exp_f32 v106, v106
    v_exp_f32 v107, v107
    v_cvt_pk_bf16_f32 v46, v104, v105
    v_cvt_pk_bf16_f32 v47, v106, v107
    s_waitcnt lgkmcnt(1)
    v_mfma_f32_32x32x16_bf16 v[52:67], v[32:35], v[40:43], v[52:67]
    v_exp_f32 v108, v108
    v_exp_f32 v109, v109
    v_exp_f32 v110, v110
    v_exp_f32 v111, v111
    v_cvt_pk_bf16_f32 v48, v108, v109
    v_cvt_pk_bf16_f32 v49, v110, v111
    v_mfma_f32_32x32x16_bf16 v[68:83], v[28:31], v[44:47], v[68:83]
    ds_read_b128 v[28:31], v162 offset:3520
    v_exp_f32 v112, v112
    v_exp_f32 v113, v113
    v_exp_f32 v114, v114
    v_exp_f32 v115, v115
    v_cvt_pk_bf16_f32 v50, v112, v113
    v_cvt_pk_bf16_f32 v51, v114, v115
    v_mfma_f32_32x32x4bf16_1k v[84:115], v[22:23], v[20:21], 0 cbsz:1 abid:0
    s_setprio 0
    v_exp_f32 v116, v116
    v_exp_f32 v117, v117
    v_exp_f32 v118, v118
    v_exp_f32 v119, v119
    v_cvt_pk_bf16_f32 v36, v116, v117
    v_cvt_pk_bf16_f32 v37, v118, v119
    v_exp_f32 v120, v120
    v_exp_f32 v121, v121
    v_exp_f32 v122, v122
    v_exp_f32 v123, v123
    v_cvt_pk_bf16_f32 v38, v120, v121
    v_cvt_pk_bf16_f32 v39, v122, v123
    v_mfma_f32_32x32x16_bf16 v[68:83], v[32:35], v[48:51], v[68:83]
    ds_read_b128 v[32:35], v162 offset:4224
    v_exp_f32 v124, v124
    v_exp_f32 v125, v125
    v_exp_f32 v126, v126
    v_exp_f32 v127, v127
    v_cvt_pk_bf16_f32 v40, v124, v125
    v_cvt_pk_bf16_f32 v41, v126, v127
    s_waitcnt lgkmcnt(1)
    v_mfma_f32_32x32x16_bf16 v[84:99], v[24:27], v[12:15], v[84:99]
    v_exp_f32 v128, v128
    v_exp_f32 v129, v129
    v_exp_f32 v130, v130
    v_exp_f32 v131, v131
    v_cvt_pk_bf16_f32 v42, v128, v129
    v_cvt_pk_bf16_f32 v43, v130, v131
    v_mfma_f32_32x32x16_bf16 v[52:67], v[28:31], v[36:39], v[52:67]
    v_exp_f32 v132, v132
    v_exp_f32 v133, v133
    v_exp_f32 v134, v134
    v_exp_f32 v135, v135
    v_cvt_pk_bf16_f32 v44, v132, v133
    v_cvt_pk_bf16_f32 v45, v134, v135
    v_mfma_f32_32x32x16_bf16 v[100:115], v[24:27], v[16:19], v[100:115]
    ds_read_b128 v[24:27], v160 offset:3584
    v_exp_f32 v136, v136
    v_exp_f32 v137, v137
    v_exp_f32 v138, v138
    v_exp_f32 v139, v139
    v_cvt_pk_bf16_f32 v46, v136, v137
    v_cvt_pk_bf16_f32 v47, v138, v139
    s_waitcnt lgkmcnt(1)
    v_mfma_f32_32x32x16_bf16 v[52:67], v[32:35], v[40:43], v[52:67]
    v_exp_f32 v140, v140
    v_exp_f32 v141, v141
    v_exp_f32 v142, v142
    v_exp_f32 v143, v143
    v_cvt_pk_bf16_f32 v48, v140, v141
    v_cvt_pk_bf16_f32 v49, v142, v143
    v_mfma_f32_32x32x16_bf16 v[68:83], v[28:31], v[44:47], v[68:83]
    ds_read_b128 v[28:31], v162 offset:4928
    v_exp_f32 v144, v144
    v_exp_f32 v145, v145
    v_exp_f32 v146, v146
    v_exp_f32 v147, v147
    v_cvt_pk_bf16_f32 v50, v144, v145
    v_cvt_pk_bf16_f32 v51, v146, v147
    s_waitcnt lgkmcnt(0)
    s_barrier
    v_mfma_f32_32x32x4bf16_1k v[116:147], v[22:23], v[20:21], 0 cbsz:1 abid:1
    ds_read_b64 v[22:23], v161 offset:23552
    s_setprio 3
    v_exp_f32 v84, v84
    v_exp_f32 v85, v85
    v_exp_f32 v86, v86
    v_exp_f32 v87, v87
    v_cvt_pk_bf16_f32 v36, v84, v85
    v_cvt_pk_bf16_f32 v37, v86, v87
    v_exp_f32 v88, v88
    v_exp_f32 v89, v89
    v_exp_f32 v90, v90
    v_exp_f32 v91, v91
    v_cvt_pk_bf16_f32 v38, v88, v89
    v_cvt_pk_bf16_f32 v39, v90, v91
    v_mfma_f32_32x32x16_bf16 v[68:83], v[32:35], v[48:51], v[68:83]
    ds_read_b128 v[32:35], v162 offset:21504
    v_exp_f32 v92, v92
    v_exp_f32 v93, v93
    v_exp_f32 v94, v94
    v_exp_f32 v95, v95
    v_cvt_pk_bf16_f32 v40, v92, v93
    v_cvt_pk_bf16_f32 v41, v94, v95
    s_waitcnt lgkmcnt(2)
    v_mfma_f32_32x32x16_bf16 v[116:131], v[24:27], v[12:15], v[116:131]
    v_exp_f32 v96, v96
    v_exp_f32 v97, v97
    v_exp_f32 v98, v98
    v_exp_f32 v99, v99
    v_cvt_pk_bf16_f32 v42, v96, v97
    v_cvt_pk_bf16_f32 v43, v98, v99
    v_mfma_f32_32x32x16_bf16 v[52:67], v[28:31], v[36:39], v[52:67]
    v_exp_f32 v100, v100
    v_exp_f32 v101, v101
    v_exp_f32 v102, v102
    v_exp_f32 v103, v103
    v_cvt_pk_bf16_f32 v44, v100, v101
    v_cvt_pk_bf16_f32 v45, v102, v103
    v_mfma_f32_32x32x16_bf16 v[132:147], v[24:27], v[16:19], v[132:147]
    ds_read_b128 v[24:27], v160 offset:21504
    v_exp_f32 v104, v104
    v_exp_f32 v105, v105
    v_exp_f32 v106, v106
    v_exp_f32 v107, v107
    v_cvt_pk_bf16_f32 v46, v104, v105
    v_cvt_pk_bf16_f32 v47, v106, v107
    s_waitcnt lgkmcnt(1)
    v_mfma_f32_32x32x16_bf16 v[52:67], v[32:35], v[40:43], v[52:67]
    v_exp_f32 v108, v108
    v_exp_f32 v109, v109
    v_exp_f32 v110, v110
    v_exp_f32 v111, v111
    v_cvt_pk_bf16_f32 v48, v108, v109
    v_cvt_pk_bf16_f32 v49, v110, v111
    v_mfma_f32_32x32x16_bf16 v[68:83], v[28:31], v[44:47], v[68:83]
    ds_read_b128 v[28:31], v162 offset:22208
    v_exp_f32 v112, v112
    v_exp_f32 v113, v113
    v_exp_f32 v114, v114
    v_exp_f32 v115, v115
    v_cvt_pk_bf16_f32 v50, v112, v113
    v_cvt_pk_bf16_f32 v51, v114, v115
    v_mfma_f32_32x32x4bf16_1k v[84:115], v[22:23], v[20:21], 0 cbsz:1 abid:0
    s_setprio 2
    v_exp_f32 v116, v116
    v_exp_f32 v117, v117
    v_exp_f32 v118, v118
    v_exp_f32 v119, v119
    v_cvt_pk_bf16_f32 v36, v116, v117
    v_cvt_pk_bf16_f32 v37, v118, v119
    v_exp_f32 v120, v120
    v_exp_f32 v121, v121
    v_exp_f32 v122, v122
    v_exp_f32 v123, v123
    v_cvt_pk_bf16_f32 v38, v120, v121
    v_cvt_pk_bf16_f32 v39, v122, v123
    v_mfma_f32_32x32x16_bf16 v[68:83], v[32:35], v[48:51], v[68:83]
    ds_read_b128 v[32:35], v162 offset:22912
    v_exp_f32 v124, v124
    v_exp_f32 v125, v125
    v_exp_f32 v126, v126
    v_exp_f32 v127, v127
    v_cvt_pk_bf16_f32 v40, v124, v125
    v_cvt_pk_bf16_f32 v41, v126, v127
    s_waitcnt lgkmcnt(1)
    v_mfma_f32_32x32x16_bf16 v[84:99], v[24:27], v[12:15], v[84:99]
    v_exp_f32 v128, v128
    v_exp_f32 v129, v129
    v_exp_f32 v130, v130
    v_exp_f32 v131, v131
    v_cvt_pk_bf16_f32 v42, v128, v129
    v_cvt_pk_bf16_f32 v43, v130, v131
    v_mfma_f32_32x32x16_bf16 v[52:67], v[28:31], v[36:39], v[52:67]
    v_exp_f32 v132, v132
    v_exp_f32 v133, v133
    v_exp_f32 v134, v134
    v_exp_f32 v135, v135
    v_cvt_pk_bf16_f32 v44, v132, v133
    v_cvt_pk_bf16_f32 v45, v134, v135
    v_mfma_f32_32x32x16_bf16 v[100:115], v[24:27], v[16:19], v[100:115]
    ds_read_b128 v[24:27], v160 offset:22528
    v_exp_f32 v136, v136
    v_exp_f32 v137, v137
    v_exp_f32 v138, v138
    v_exp_f32 v139, v139
    v_cvt_pk_bf16_f32 v46, v136, v137
    v_cvt_pk_bf16_f32 v47, v138, v139
    s_waitcnt lgkmcnt(1)
    v_mfma_f32_32x32x16_bf16 v[52:67], v[32:35], v[40:43], v[52:67]
    v_exp_f32 v140, v140
    v_exp_f32 v141, v141
    v_exp_f32 v142, v142
    v_exp_f32 v143, v143
    v_cvt_pk_bf16_f32 v48, v140, v141
    v_cvt_pk_bf16_f32 v49, v142, v143
    v_mfma_f32_32x32x16_bf16 v[68:83], v[28:31], v[44:47], v[68:83]
    ds_read_b128 v[28:31], v162 offset:23616
    v_exp_f32 v144, v144
    v_exp_f32 v145, v145
    v_exp_f32 v146, v146
    v_exp_f32 v147, v147
    v_cvt_pk_bf16_f32 v50, v144, v145
    v_cvt_pk_bf16_f32 v51, v146, v147
    v_mfma_f32_32x32x4bf16_1k v[116:147], v[22:23], v[20:21], 0 cbsz:1 abid:1
    ds_read_b64 v[22:23], v161 offset:26112
    s_setprio 1
    v_exp_f32 v84, v84
    v_exp_f32 v85, v85
    v_exp_f32 v86, v86
    v_exp_f32 v87, v87
    v_cvt_pk_bf16_f32 v36, v84, v85
    v_cvt_pk_bf16_f32 v37, v86, v87
    v_exp_f32 v88, v88
    v_exp_f32 v89, v89
    v_exp_f32 v90, v90
    v_exp_f32 v91, v91
    v_cvt_pk_bf16_f32 v38, v88, v89
    v_cvt_pk_bf16_f32 v39, v90, v91
    v_mfma_f32_32x32x16_bf16 v[68:83], v[32:35], v[48:51], v[68:83]
    ds_read_b128 v[32:35], v162 offset:24320
    v_exp_f32 v92, v92
    v_exp_f32 v93, v93
    v_exp_f32 v94, v94
    v_exp_f32 v95, v95
    v_cvt_pk_bf16_f32 v40, v92, v93
    v_cvt_pk_bf16_f32 v41, v94, v95
    s_waitcnt lgkmcnt(2)
    v_mfma_f32_32x32x16_bf16 v[116:131], v[24:27], v[12:15], v[116:131]
    v_exp_f32 v96, v96
    v_exp_f32 v97, v97
    v_exp_f32 v98, v98
    v_exp_f32 v99, v99
    v_cvt_pk_bf16_f32 v42, v96, v97
    v_cvt_pk_bf16_f32 v43, v98, v99
    v_mfma_f32_32x32x16_bf16 v[52:67], v[28:31], v[36:39], v[52:67]
    v_exp_f32 v100, v100
    v_exp_f32 v101, v101
    v_exp_f32 v102, v102
    v_exp_f32 v103, v103
    v_cvt_pk_bf16_f32 v44, v100, v101
    v_cvt_pk_bf16_f32 v45, v102, v103
    v_mfma_f32_32x32x16_bf16 v[132:147], v[24:27], v[16:19], v[132:147]
    ds_read_b128 v[24:27], v160 offset:24064
    v_exp_f32 v104, v104
    v_exp_f32 v105, v105
    v_exp_f32 v106, v106
    v_exp_f32 v107, v107
    v_cvt_pk_bf16_f32 v46, v104, v105
    v_cvt_pk_bf16_f32 v47, v106, v107
    s_waitcnt lgkmcnt(1)
    v_mfma_f32_32x32x16_bf16 v[52:67], v[32:35], v[40:43], v[52:67]
    v_exp_f32 v108, v108
    v_exp_f32 v109, v109
    v_exp_f32 v110, v110
    v_exp_f32 v111, v111
    v_cvt_pk_bf16_f32 v48, v108, v109
    v_cvt_pk_bf16_f32 v49, v110, v111
    v_mfma_f32_32x32x16_bf16 v[68:83], v[28:31], v[44:47], v[68:83]
    ds_read_b128 v[28:31], v162 offset:25024
    v_exp_f32 v112, v112
    v_exp_f32 v113, v113
    v_exp_f32 v114, v114
    v_exp_f32 v115, v115
    v_cvt_pk_bf16_f32 v50, v112, v113
    v_cvt_pk_bf16_f32 v51, v114, v115
    v_mfma_f32_32x32x4bf16_1k v[84:115], v[22:23], v[20:21], 0 cbsz:1 abid:0
    s_setprio 0
    v_exp_f32 v116, v116
    v_exp_f32 v117, v117
    v_exp_f32 v118, v118
    v_exp_f32 v119, v119
    v_cvt_pk_bf16_f32 v36, v116, v117
    v_cvt_pk_bf16_f32 v37, v118, v119
    v_exp_f32 v120, v120
    v_exp_f32 v121, v121
    v_exp_f32 v122, v122
    v_exp_f32 v123, v123
    v_cvt_pk_bf16_f32 v38, v120, v121
    v_cvt_pk_bf16_f32 v39, v122, v123
    v_mfma_f32_32x32x16_bf16 v[68:83], v[32:35], v[48:51], v[68:83]
    ds_read_b128 v[32:35], v162 offset:25728
    v_exp_f32 v124, v124
    v_exp_f32 v125, v125
    v_exp_f32 v126, v126
    v_exp_f32 v127, v127
    v_cvt_pk_bf16_f32 v40, v124, v125
    v_cvt_pk_bf16_f32 v41, v126, v127
    s_waitcnt lgkmcnt(1)
    v_mfma_f32_32x32x16_bf16 v[84:99], v[24:27], v[12:15], v[84:99]
    v_exp_f32 v128, v128
    v_exp_f32 v129, v129
    v_exp_f32 v130, v130
    v_exp_f32 v131, v131
    v_cvt_pk_bf16_f32 v42, v128, v129
    v_cvt_pk_bf16_f32 v43, v130, v131
    v_mfma_f32_32x32x16_bf16 v[52:67], v[28:31], v[36:39], v[52:67]
    v_exp_f32 v132, v132
    v_exp_f32 v133, v133
    v_exp_f32 v134, v134
    v_exp_f32 v135, v135
    v_cvt_pk_bf16_f32 v44, v132, v133
    v_cvt_pk_bf16_f32 v45, v134, v135
    v_mfma_f32_32x32x16_bf16 v[100:115], v[24:27], v[16:19], v[100:115]
    ds_read_b128 v[24:27], v160 offset:25088
    v_exp_f32 v136, v136
    v_exp_f32 v137, v137
    v_exp_f32 v138, v138
    v_exp_f32 v139, v139
    v_cvt_pk_bf16_f32 v46, v136, v137
    v_cvt_pk_bf16_f32 v47, v138, v139
    s_waitcnt lgkmcnt(1)
    v_mfma_f32_32x32x16_bf16 v[52:67], v[32:35], v[40:43], v[52:67]
    v_exp_f32 v140, v140
    v_exp_f32 v141, v141
    v_exp_f32 v142, v142
    v_exp_f32 v143, v143
    v_cvt_pk_bf16_f32 v48, v140, v141
    v_cvt_pk_bf16_f32 v49, v142, v143
    v_mfma_f32_32x32x16_bf16 v[68:83], v[28:31], v[44:47], v[68:83]
    ds_read_b128 v[28:31], v162 offset:26432
    v_exp_f32 v144, v144
    v_exp_f32 v145, v145
    v_exp_f32 v146, v146
    v_exp_f32 v147, v147
    v_cvt_pk_bf16_f32 v50, v144, v145
    v_cvt_pk_bf16_f32 v51, v146, v147
    s_waitcnt lgkmcnt(0)
    s_barrier
    v_mfma_f32_32x32x4bf16_1k v[116:147], v[22:23], v[20:21], 0 cbsz:1 abid:1
    ds_read_b64 v[22:23], v161 offset:45056
    s_setprio 3
    v_exp_f32 v84, v84
    v_exp_f32 v85, v85
    v_exp_f32 v86, v86
    v_exp_f32 v87, v87
    v_cvt_pk_bf16_f32 v36, v84, v85
    v_cvt_pk_bf16_f32 v37, v86, v87
    v_exp_f32 v88, v88
    v_exp_f32 v89, v89
    v_exp_f32 v90, v90
    v_exp_f32 v91, v91
    v_cvt_pk_bf16_f32 v38, v88, v89
    v_cvt_pk_bf16_f32 v39, v90, v91
    v_mfma_f32_32x32x16_bf16 v[68:83], v[32:35], v[48:51], v[68:83]
    ds_read_b128 v[32:35], v162 offset:43008
    v_exp_f32 v92, v92
    v_exp_f32 v93, v93
    v_exp_f32 v94, v94
    v_exp_f32 v95, v95
    v_cvt_pk_bf16_f32 v40, v92, v93
    v_cvt_pk_bf16_f32 v41, v94, v95
    s_waitcnt lgkmcnt(2)
    v_mfma_f32_32x32x16_bf16 v[116:131], v[24:27], v[12:15], v[116:131]
    v_exp_f32 v96, v96
    v_exp_f32 v97, v97
    v_exp_f32 v98, v98
    v_exp_f32 v99, v99
    v_cvt_pk_bf16_f32 v42, v96, v97
    v_cvt_pk_bf16_f32 v43, v98, v99
    v_mfma_f32_32x32x16_bf16 v[52:67], v[28:31], v[36:39], v[52:67]
    v_exp_f32 v100, v100
    v_exp_f32 v101, v101
    v_exp_f32 v102, v102
    v_exp_f32 v103, v103
    v_cvt_pk_bf16_f32 v44, v100, v101
    v_cvt_pk_bf16_f32 v45, v102, v103
    v_mfma_f32_32x32x16_bf16 v[132:147], v[24:27], v[16:19], v[132:147]
    ds_read_b128 v[24:27], v160 offset:43008
    v_exp_f32 v104, v104
    v_exp_f32 v105, v105
    v_exp_f32 v106, v106
    v_exp_f32 v107, v107
    v_cvt_pk_bf16_f32 v46, v104, v105
    v_cvt_pk_bf16_f32 v47, v106, v107
    s_waitcnt lgkmcnt(1)
    v_mfma_f32_32x32x16_bf16 v[52:67], v[32:35], v[40:43], v[52:67]
    v_exp_f32 v108, v108
    v_exp_f32 v109, v109
    v_exp_f32 v110, v110
    v_exp_f32 v111, v111
    v_cvt_pk_bf16_f32 v48, v108, v109
    v_cvt_pk_bf16_f32 v49, v110, v111
    v_mfma_f32_32x32x16_bf16 v[68:83], v[28:31], v[44:47], v[68:83]
    ds_read_b128 v[28:31], v162 offset:43712
    v_exp_f32 v112, v112
    v_exp_f32 v113, v113
    v_exp_f32 v114, v114
    v_exp_f32 v115, v115
    v_cvt_pk_bf16_f32 v50, v112, v113
    v_cvt_pk_bf16_f32 v51, v114, v115
    v_mfma_f32_32x32x4bf16_1k v[84:115], v[22:23], v[20:21], 0 cbsz:1 abid:0
    s_setprio 2
    v_exp_f32 v116, v116
    v_exp_f32 v117, v117
    v_exp_f32 v118, v118
    v_exp_f32 v119, v119
    v_cvt_pk_bf16_f32 v36, v116, v117
    v_cvt_pk_bf16_f32 v37, v118, v119
    v_exp_f32 v120, v120
    v_exp_f32 v121, v121
    v_exp_f32 v122, v122
    v_exp_f32 v123, v123
    v_cvt_pk_bf16_f32 v38, v120, v121
    v_cvt_pk_bf16_f32 v39, v122, v123
    v_mfma_f32_32x32x16_bf16 v[68:83], v[32:35], v[48:51], v[68:83]
    ds_read_b128 v[32:35], v162 offset:44416
    v_exp_f32 v124, v124
    v_exp_f32 v125, v125
    v_exp_f32 v126, v126
    v_exp_f32 v127, v127
    v_cvt_pk_bf16_f32 v40, v124, v125
    v_cvt_pk_bf16_f32 v41, v126, v127
    s_waitcnt lgkmcnt(1)
    v_mfma_f32_32x32x16_bf16 v[84:99], v[24:27], v[12:15], v[84:99]
    v_exp_f32 v128, v128
    v_exp_f32 v129, v129
    v_exp_f32 v130, v130
    v_exp_f32 v131, v131
    v_cvt_pk_bf16_f32 v42, v128, v129
    v_cvt_pk_bf16_f32 v43, v130, v131
    v_mfma_f32_32x32x16_bf16 v[52:67], v[28:31], v[36:39], v[52:67]
    v_exp_f32 v132, v132
    v_exp_f32 v133, v133
    v_exp_f32 v134, v134
    v_exp_f32 v135, v135
    v_cvt_pk_bf16_f32 v44, v132, v133
    v_cvt_pk_bf16_f32 v45, v134, v135
    v_mfma_f32_32x32x16_bf16 v[100:115], v[24:27], v[16:19], v[100:115]
    ds_read_b128 v[24:27], v160 offset:44032
    v_exp_f32 v136, v136
    v_exp_f32 v137, v137
    v_exp_f32 v138, v138
    v_exp_f32 v139, v139
    v_cvt_pk_bf16_f32 v46, v136, v137
    v_cvt_pk_bf16_f32 v47, v138, v139
    s_waitcnt lgkmcnt(1)
    v_mfma_f32_32x32x16_bf16 v[52:67], v[32:35], v[40:43], v[52:67]
    v_exp_f32 v140, v140
    v_exp_f32 v141, v141
    v_exp_f32 v142, v142
    v_exp_f32 v143, v143
    v_cvt_pk_bf16_f32 v48, v140, v141
    v_cvt_pk_bf16_f32 v49, v142, v143
    v_mfma_f32_32x32x16_bf16 v[68:83], v[28:31], v[44:47], v[68:83]
    ds_read_b128 v[28:31], v162 offset:45120
    v_exp_f32 v144, v144
    v_exp_f32 v145, v145
    v_exp_f32 v146, v146
    v_exp_f32 v147, v147
    v_cvt_pk_bf16_f32 v50, v144, v145
    v_cvt_pk_bf16_f32 v51, v146, v147
    v_mfma_f32_32x32x4bf16_1k v[116:147], v[22:23], v[20:21], 0 cbsz:1 abid:1
    ds_read_b64 v[22:23], v161 offset:47616
    s_setprio 1
    v_exp_f32 v84, v84
    v_exp_f32 v85, v85
    v_exp_f32 v86, v86
    v_exp_f32 v87, v87
    v_cvt_pk_bf16_f32 v36, v84, v85
    v_cvt_pk_bf16_f32 v37, v86, v87
    v_exp_f32 v88, v88
    v_exp_f32 v89, v89
    v_exp_f32 v90, v90
    v_exp_f32 v91, v91
    v_cvt_pk_bf16_f32 v38, v88, v89
    v_cvt_pk_bf16_f32 v39, v90, v91
    v_mfma_f32_32x32x16_bf16 v[68:83], v[32:35], v[48:51], v[68:83]
    ds_read_b128 v[32:35], v162 offset:45824
    v_exp_f32 v92, v92
    v_exp_f32 v93, v93
    v_exp_f32 v94, v94
    v_exp_f32 v95, v95
    v_cvt_pk_bf16_f32 v40, v92, v93
    v_cvt_pk_bf16_f32 v41, v94, v95
    s_waitcnt lgkmcnt(2)
    v_mfma_f32_32x32x16_bf16 v[116:131], v[24:27], v[12:15], v[116:131]
    v_exp_f32 v96, v96
    v_exp_f32 v97, v97
    v_exp_f32 v98, v98
    v_exp_f32 v99, v99
    v_cvt_pk_bf16_f32 v42, v96, v97
    v_cvt_pk_bf16_f32 v43, v98, v99
    v_mfma_f32_32x32x16_bf16 v[52:67], v[28:31], v[36:39], v[52:67]
    v_exp_f32 v100, v100
    v_exp_f32 v101, v101
    v_exp_f32 v102, v102
    v_exp_f32 v103, v103
    v_cvt_pk_bf16_f32 v44, v100, v101
    v_cvt_pk_bf16_f32 v45, v102, v103
    v_mfma_f32_32x32x16_bf16 v[132:147], v[24:27], v[16:19], v[132:147]
    ds_read_b128 v[24:27], v160 offset:45568
    v_exp_f32 v104, v104
    v_exp_f32 v105, v105
    v_exp_f32 v106, v106
    v_exp_f32 v107, v107
    v_cvt_pk_bf16_f32 v46, v104, v105
    v_cvt_pk_bf16_f32 v47, v106, v107
    s_waitcnt lgkmcnt(1)
    v_mfma_f32_32x32x16_bf16 v[52:67], v[32:35], v[40:43], v[52:67]
    v_exp_f32 v108, v108
    v_exp_f32 v109, v109
    v_exp_f32 v110, v110
    v_exp_f32 v111, v111
    v_cvt_pk_bf16_f32 v48, v108, v109
    v_cvt_pk_bf16_f32 v49, v110, v111
    v_mfma_f32_32x32x16_bf16 v[68:83], v[28:31], v[44:47], v[68:83]
    ds_read_b128 v[28:31], v162 offset:46528
    v_exp_f32 v112, v112
    v_exp_f32 v113, v113
    v_exp_f32 v114, v114
    v_exp_f32 v115, v115
    v_cvt_pk_bf16_f32 v50, v112, v113
    v_cvt_pk_bf16_f32 v51, v114, v115
    v_mfma_f32_32x32x4bf16_1k v[84:115], v[22:23], v[20:21], 0 cbsz:1 abid:0
    s_setprio 0
    v_exp_f32 v116, v116
    v_exp_f32 v117, v117
    v_exp_f32 v118, v118
    v_exp_f32 v119, v119
    v_cvt_pk_bf16_f32 v36, v116, v117
    v_cvt_pk_bf16_f32 v37, v118, v119
    v_exp_f32 v120, v120
    v_exp_f32 v121, v121
    v_exp_f32 v122, v122
    v_exp_f32 v123, v123
    v_cvt_pk_bf16_f32 v38, v120, v121
    v_cvt_pk_bf16_f32 v39, v122, v123
    v_mfma_f32_32x32x16_bf16 v[68:83], v[32:35], v[48:51], v[68:83]
    ds_read_b128 v[32:35], v162 offset:47232
    v_exp_f32 v124, v124
    v_exp_f32 v125, v125
    v_exp_f32 v126, v126
    v_exp_f32 v127, v127
    v_cvt_pk_bf16_f32 v40, v124, v125
    v_cvt_pk_bf16_f32 v41, v126, v127
    s_waitcnt lgkmcnt(1)
    v_mfma_f32_32x32x16_bf16 v[84:99], v[24:27], v[12:15], v[84:99]
    v_exp_f32 v128, v128
    v_exp_f32 v129, v129
    v_exp_f32 v130, v130
    v_exp_f32 v131, v131
    v_cvt_pk_bf16_f32 v42, v128, v129
    v_cvt_pk_bf16_f32 v43, v130, v131
    v_mfma_f32_32x32x16_bf16 v[52:67], v[28:31], v[36:39], v[52:67]
    v_exp_f32 v132, v132
    v_exp_f32 v133, v133
    v_exp_f32 v134, v134
    v_exp_f32 v135, v135
    v_cvt_pk_bf16_f32 v44, v132, v133
    v_cvt_pk_bf16_f32 v45, v134, v135
    v_mfma_f32_32x32x16_bf16 v[100:115], v[24:27], v[16:19], v[100:115]
    ds_read_b128 v[24:27], v160 offset:46592
    v_exp_f32 v136, v136
    v_exp_f32 v137, v137
    v_exp_f32 v138, v138
    v_exp_f32 v139, v139
    v_cvt_pk_bf16_f32 v46, v136, v137
    v_cvt_pk_bf16_f32 v47, v138, v139
    s_waitcnt lgkmcnt(1)
    v_mfma_f32_32x32x16_bf16 v[52:67], v[32:35], v[40:43], v[52:67]
    v_exp_f32 v140, v140
    v_exp_f32 v141, v141
    v_exp_f32 v142, v142
    v_exp_f32 v143, v143
    v_cvt_pk_bf16_f32 v48, v140, v141
    v_cvt_pk_bf16_f32 v49, v142, v143
    v_mfma_f32_32x32x16_bf16 v[68:83], v[28:31], v[44:47], v[68:83]
    ds_read_b128 v[28:31], v162 offset:47936
    v_exp_f32 v144, v144
    v_exp_f32 v145, v145
    v_exp_f32 v146, v146
    v_exp_f32 v147, v147
    v_cvt_pk_bf16_f32 v50, v144, v145
    v_cvt_pk_bf16_f32 v51, v146, v147
    s_waitcnt lgkmcnt(0)
    s_barrier
    v_mfma_f32_32x32x4bf16_1k v[116:147], v[22:23], v[20:21], 0 cbsz:1 abid:1
    ds_read_b64 v[22:23], v161 offset:2048
    s_setprio 3
    v_exp_f32 v84, v84
    v_exp_f32 v85, v85
    v_exp_f32 v86, v86
    v_exp_f32 v87, v87
    v_cvt_pk_bf16_f32 v36, v84, v85
    v_cvt_pk_bf16_f32 v37, v86, v87
    v_exp_f32 v88, v88
    v_exp_f32 v89, v89
    v_exp_f32 v90, v90
    v_exp_f32 v91, v91
    v_cvt_pk_bf16_f32 v38, v88, v89
    v_cvt_pk_bf16_f32 v39, v90, v91
    v_mfma_f32_32x32x16_bf16 v[68:83], v[32:35], v[48:51], v[68:83]
    ds_read_b128 v[32:35], v162 offset:0
    v_exp_f32 v92, v92
    v_exp_f32 v93, v93
    v_exp_f32 v94, v94
    v_exp_f32 v95, v95
    v_cvt_pk_bf16_f32 v40, v92, v93
    v_cvt_pk_bf16_f32 v41, v94, v95
    s_waitcnt lgkmcnt(2)
    v_mfma_f32_32x32x16_bf16 v[116:131], v[24:27], v[12:15], v[116:131]
    v_exp_f32 v96, v96
    v_exp_f32 v97, v97
    v_exp_f32 v98, v98
    v_exp_f32 v99, v99
    v_cvt_pk_bf16_f32 v42, v96, v97
    v_cvt_pk_bf16_f32 v43, v98, v99
    v_mfma_f32_32x32x16_bf16 v[52:67], v[28:31], v[36:39], v[52:67]
    v_exp_f32 v100, v100
    v_exp_f32 v101, v101
    v_exp_f32 v102, v102
    v_exp_f32 v103, v103
    v_cvt_pk_bf16_f32 v44, v100, v101
    v_cvt_pk_bf16_f32 v45, v102, v103
    v_mfma_f32_32x32x16_bf16 v[132:147], v[24:27], v[16:19], v[132:147]
    ds_read_b128 v[24:27], v160 offset:0
    v_exp_f32 v104, v104
    v_exp_f32 v105, v105
    v_exp_f32 v106, v106
    v_exp_f32 v107, v107
    v_cvt_pk_bf16_f32 v46, v104, v105
    v_cvt_pk_bf16_f32 v47, v106, v107
    s_waitcnt lgkmcnt(1)
    v_mfma_f32_32x32x16_bf16 v[52:67], v[32:35], v[40:43], v[52:67]
    v_exp_f32 v108, v108
    v_exp_f32 v109, v109
    v_exp_f32 v110, v110
    v_exp_f32 v111, v111
    v_cvt_pk_bf16_f32 v48, v108, v109
    v_cvt_pk_bf16_f32 v49, v110, v111
    v_mfma_f32_32x32x16_bf16 v[68:83], v[28:31], v[44:47], v[68:83]
    ds_read_b128 v[28:31], v162 offset:704
    v_exp_f32 v112, v112
    v_exp_f32 v113, v113
    v_exp_f32 v114, v114
    v_exp_f32 v115, v115
    v_cvt_pk_bf16_f32 v50, v112, v113
    v_cvt_pk_bf16_f32 v51, v114, v115
    v_mfma_f32_32x32x4bf16_1k v[84:115], v[22:23], v[20:21], 0 cbsz:1 abid:0
    s_setprio 2
    v_exp_f32 v116, v116
    v_exp_f32 v117, v117
    v_exp_f32 v118, v118
    v_exp_f32 v119, v119
    v_cvt_pk_bf16_f32 v36, v116, v117
    v_cvt_pk_bf16_f32 v37, v118, v119
    v_exp_f32 v120, v120
    v_exp_f32 v121, v121
    v_exp_f32 v122, v122
    v_exp_f32 v123, v123
    v_cvt_pk_bf16_f32 v38, v120, v121
    v_cvt_pk_bf16_f32 v39, v122, v123
    v_mfma_f32_32x32x16_bf16 v[68:83], v[32:35], v[48:51], v[68:83]
    ds_read_b128 v[32:35], v162 offset:1408
    v_exp_f32 v124, v124
    v_exp_f32 v125, v125
    v_exp_f32 v126, v126
    v_exp_f32 v127, v127
    v_cvt_pk_bf16_f32 v40, v124, v125
    v_cvt_pk_bf16_f32 v41, v126, v127
    s_waitcnt lgkmcnt(1)
    v_mfma_f32_32x32x16_bf16 v[84:99], v[24:27], v[12:15], v[84:99]
    v_exp_f32 v128, v128
    v_exp_f32 v129, v129
    v_exp_f32 v130, v130
    v_exp_f32 v131, v131
    v_cvt_pk_bf16_f32 v42, v128, v129
    v_cvt_pk_bf16_f32 v43, v130, v131
    v_mfma_f32_32x32x16_bf16 v[52:67], v[28:31], v[36:39], v[52:67]
    v_exp_f32 v132, v132
    v_exp_f32 v133, v133
    v_exp_f32 v134, v134
    v_exp_f32 v135, v135
    v_cvt_pk_bf16_f32 v44, v132, v133
    v_cvt_pk_bf16_f32 v45, v134, v135
    v_mfma_f32_32x32x16_bf16 v[100:115], v[24:27], v[16:19], v[100:115]
    ds_read_b128 v[24:27], v160 offset:1024
    v_exp_f32 v136, v136
    v_exp_f32 v137, v137
    v_exp_f32 v138, v138
    v_exp_f32 v139, v139
    v_cvt_pk_bf16_f32 v46, v136, v137
    v_cvt_pk_bf16_f32 v47, v138, v139
    s_waitcnt lgkmcnt(1)
    v_mfma_f32_32x32x16_bf16 v[52:67], v[32:35], v[40:43], v[52:67]
    v_exp_f32 v140, v140
    v_exp_f32 v141, v141
    v_exp_f32 v142, v142
    v_exp_f32 v143, v143
    v_cvt_pk_bf16_f32 v48, v140, v141
    v_cvt_pk_bf16_f32 v49, v142, v143
    v_mfma_f32_32x32x16_bf16 v[68:83], v[28:31], v[44:47], v[68:83]
    ds_read_b128 v[28:31], v162 offset:2112
    v_exp_f32 v144, v144
    v_exp_f32 v145, v145
    v_exp_f32 v146, v146
    v_exp_f32 v147, v147
    v_cvt_pk_bf16_f32 v50, v144, v145
    v_cvt_pk_bf16_f32 v51, v146, v147
    v_mfma_f32_32x32x4bf16_1k v[116:147], v[22:23], v[20:21], 0 cbsz:1 abid:1
    ds_read_b64 v[22:23], v161 offset:4608
    s_setprio 1
    v_exp_f32 v84, v84
    v_exp_f32 v85, v85
    v_exp_f32 v86, v86
    v_exp_f32 v87, v87
    v_cvt_pk_bf16_f32 v36, v84, v85
    v_cvt_pk_bf16_f32 v37, v86, v87
    v_exp_f32 v88, v88
    v_exp_f32 v89, v89
    v_exp_f32 v90, v90
    v_exp_f32 v91, v91
    v_cvt_pk_bf16_f32 v38, v88, v89
    v_cvt_pk_bf16_f32 v39, v90, v91
    v_mfma_f32_32x32x16_bf16 v[68:83], v[32:35], v[48:51], v[68:83]
    ds_read_b128 v[32:35], v162 offset:2816
    v_exp_f32 v92, v92
    v_exp_f32 v93, v93
    v_exp_f32 v94, v94
    v_exp_f32 v95, v95
    v_cvt_pk_bf16_f32 v40, v92, v93
    v_cvt_pk_bf16_f32 v41, v94, v95
    s_waitcnt lgkmcnt(2)
    v_mfma_f32_32x32x16_bf16 v[116:131], v[24:27], v[12:15], v[116:131]
    v_exp_f32 v96, v96
    v_exp_f32 v97, v97
    v_exp_f32 v98, v98
    v_exp_f32 v99, v99
    v_cvt_pk_bf16_f32 v42, v96, v97
    v_cvt_pk_bf16_f32 v43, v98, v99
    v_mfma_f32_32x32x16_bf16 v[52:67], v[28:31], v[36:39], v[52:67]
    v_exp_f32 v100, v100
    v_exp_f32 v101, v101
    v_exp_f32 v102, v102
    v_exp_f32 v103, v103
    v_cvt_pk_bf16_f32 v44, v100, v101
    v_cvt_pk_bf16_f32 v45, v102, v103
    v_mfma_f32_32x32x16_bf16 v[132:147], v[24:27], v[16:19], v[132:147]
    ds_read_b128 v[24:27], v160 offset:2560
    v_exp_f32 v104, v104
    v_exp_f32 v105, v105
    v_exp_f32 v106, v106
    v_exp_f32 v107, v107
    v_cvt_pk_bf16_f32 v46, v104, v105
    v_cvt_pk_bf16_f32 v47, v106, v107
    s_waitcnt lgkmcnt(1)
    v_mfma_f32_32x32x16_bf16 v[52:67], v[32:35], v[40:43], v[52:67]
    v_exp_f32 v108, v108
    v_exp_f32 v109, v109
    v_exp_f32 v110, v110
    v_exp_f32 v111, v111
    v_cvt_pk_bf16_f32 v48, v108, v109
    v_cvt_pk_bf16_f32 v49, v110, v111
    v_mfma_f32_32x32x16_bf16 v[68:83], v[28:31], v[44:47], v[68:83]
    ds_read_b128 v[28:31], v162 offset:3520
    v_exp_f32 v112, v112
    v_exp_f32 v113, v113
    v_exp_f32 v114, v114
    v_exp_f32 v115, v115
    v_cvt_pk_bf16_f32 v50, v112, v113
    v_cvt_pk_bf16_f32 v51, v114, v115
    v_mfma_f32_32x32x4bf16_1k v[84:115], v[22:23], v[20:21], 0 cbsz:1 abid:0
    s_setprio 0
    v_exp_f32 v116, v116
    v_exp_f32 v117, v117
    v_exp_f32 v118, v118
    v_exp_f32 v119, v119
    v_cvt_pk_bf16_f32 v36, v116, v117
    v_cvt_pk_bf16_f32 v37, v118, v119
    v_exp_f32 v120, v120
    v_exp_f32 v121, v121
    v_exp_f32 v122, v122
    v_exp_f32 v123, v123
    v_cvt_pk_bf16_f32 v38, v120, v121
    v_cvt_pk_bf16_f32 v39, v122, v123
    v_mfma_f32_32x32x16_bf16 v[68:83], v[32:35], v[48:51], v[68:83]
    ds_read_b128 v[32:35], v162 offset:4224
    v_exp_f32 v124, v124
    v_exp_f32 v125, v125
    v_exp_f32 v126, v126
    v_exp_f32 v127, v127
    v_cvt_pk_bf16_f32 v40, v124, v125
    v_cvt_pk_bf16_f32 v41, v126, v127
    s_waitcnt lgkmcnt(1)
    v_mfma_f32_32x32x16_bf16 v[84:99], v[24:27], v[12:15], v[84:99]
    v_exp_f32 v128, v128
    v_exp_f32 v129, v129
    v_exp_f32 v130, v130
    v_exp_f32 v131, v131
    v_cvt_pk_bf16_f32 v42, v128, v129
    v_cvt_pk_bf16_f32 v43, v130, v131
    v_mfma_f32_32x32x16_bf16 v[52:67], v[28:31], v[36:39], v[52:67]
    v_exp_f32 v132, v132
    v_exp_f32 v133, v133
    v_exp_f32 v134, v134
    v_exp_f32 v135, v135
    v_cvt_pk_bf16_f32 v44, v132, v133
    v_cvt_pk_bf16_f32 v45, v134, v135
    v_mfma_f32_32x32x16_bf16 v[100:115], v[24:27], v[16:19], v[100:115]
    ds_read_b128 v[24:27], v160 offset:3584
    v_exp_f32 v136, v136
    v_exp_f32 v137, v137
    v_exp_f32 v138, v138
    v_exp_f32 v139, v139
    v_cvt_pk_bf16_f32 v46, v136, v137
    v_cvt_pk_bf16_f32 v47, v138, v139
    s_waitcnt lgkmcnt(1)
    v_mfma_f32_32x32x16_bf16 v[52:67], v[32:35], v[40:43], v[52:67]
    v_exp_f32 v140, v140
    v_exp_f32 v141, v141
    v_exp_f32 v142, v142
    v_exp_f32 v143, v143
    v_cvt_pk_bf16_f32 v48, v140, v141
    v_cvt_pk_bf16_f32 v49, v142, v143
    v_mfma_f32_32x32x16_bf16 v[68:83], v[28:31], v[44:47], v[68:83]
    ds_read_b128 v[28:31], v162 offset:4928
    v_exp_f32 v144, v144
    v_exp_f32 v145, v145
    v_exp_f32 v146, v146
    v_exp_f32 v147, v147
    v_cvt_pk_bf16_f32 v50, v144, v145
    v_cvt_pk_bf16_f32 v51, v146, v147
    s_waitcnt lgkmcnt(0)
    s_barrier
    v_mfma_f32_32x32x4bf16_1k v[116:147], v[22:23], v[20:21], 0 cbsz:1 abid:1
    ds_read_b64 v[22:23], v161 offset:23552
    s_setprio 3
    v_exp_f32 v84, v84
    v_exp_f32 v85, v85
    v_exp_f32 v86, v86
    v_exp_f32 v87, v87
    v_cvt_pk_bf16_f32 v36, v84, v85
    v_cvt_pk_bf16_f32 v37, v86, v87
    v_exp_f32 v88, v88
    v_exp_f32 v89, v89
    v_exp_f32 v90, v90
    v_exp_f32 v91, v91
    v_cvt_pk_bf16_f32 v38, v88, v89
    v_cvt_pk_bf16_f32 v39, v90, v91
    v_mfma_f32_32x32x16_bf16 v[68:83], v[32:35], v[48:51], v[68:83]
    ds_read_b128 v[32:35], v162 offset:21504
    v_exp_f32 v92, v92
    v_exp_f32 v93, v93
    v_exp_f32 v94, v94
    v_exp_f32 v95, v95
    v_cvt_pk_bf16_f32 v40, v92, v93
    v_cvt_pk_bf16_f32 v41, v94, v95
    s_waitcnt lgkmcnt(2)
    v_mfma_f32_32x32x16_bf16 v[116:131], v[24:27], v[12:15], v[116:131]
    v_exp_f32 v96, v96
    v_exp_f32 v97, v97
    v_exp_f32 v98, v98
    v_exp_f32 v99, v99
    v_cvt_pk_bf16_f32 v42, v96, v97
    v_cvt_pk_bf16_f32 v43, v98, v99
    v_mfma_f32_32x32x16_bf16 v[52:67], v[28:31], v[36:39], v[52:67]
    v_exp_f32 v100, v100
    v_exp_f32 v101, v101
    v_exp_f32 v102, v102
    v_exp_f32 v103, v103
    v_cvt_pk_bf16_f32 v44, v100, v101
    v_cvt_pk_bf16_f32 v45, v102, v103
    v_mfma_f32_32x32x16_bf16 v[132:147], v[24:27], v[16:19], v[132:147]
    ds_read_b128 v[24:27], v160 offset:21504
    v_exp_f32 v104, v104
    v_exp_f32 v105, v105
    v_exp_f32 v106, v106
    v_exp_f32 v107, v107
    v_cvt_pk_bf16_f32 v46, v104, v105
    v_cvt_pk_bf16_f32 v47, v106, v107
    s_waitcnt lgkmcnt(1)
    v_mfma_f32_32x32x16_bf16 v[52:67], v[32:35], v[40:43], v[52:67]
    v_exp_f32 v108, v108
    v_exp_f32 v109, v109
    v_exp_f32 v110, v110
    v_exp_f32 v111, v111
    v_cvt_pk_bf16_f32 v48, v108, v109
    v_cvt_pk_bf16_f32 v49, v110, v111
    v_mfma_f32_32x32x16_bf16 v[68:83], v[28:31], v[44:47], v[68:83]
    ds_read_b128 v[28:31], v162 offset:22208
    v_exp_f32 v112, v112
    v_exp_f32 v113, v113
    v_exp_f32 v114, v114
    v_exp_f32 v115, v115
    v_cvt_pk_bf16_f32 v50, v112, v113
    v_cvt_pk_bf16_f32 v51, v114, v115
    v_mfma_f32_32x32x4bf16_1k v[84:115], v[22:23], v[20:21], 0 cbsz:1 abid:0
    s_setprio 2
    v_exp_f32 v116, v116
    v_exp_f32 v117, v117
    v_exp_f32 v118, v118
    v_exp_f32 v119, v119
    v_cvt_pk_bf16_f32 v36, v116, v117
    v_cvt_pk_bf16_f32 v37, v118, v119
    v_exp_f32 v120, v120
    v_exp_f32 v121, v121
    v_exp_f32 v122, v122
    v_exp_f32 v123, v123
    v_cvt_pk_bf16_f32 v38, v120, v121
    v_cvt_pk_bf16_f32 v39, v122, v123
    v_mfma_f32_32x32x16_bf16 v[68:83], v[32:35], v[48:51], v[68:83]
    ds_read_b128 v[32:35], v162 offset:22912
    v_exp_f32 v124, v124
    v_exp_f32 v125, v125
    v_exp_f32 v126, v126
    v_exp_f32 v127, v127
    v_cvt_pk_bf16_f32 v40, v124, v125
    v_cvt_pk_bf16_f32 v41, v126, v127
    s_waitcnt lgkmcnt(1)
    v_mfma_f32_32x32x16_bf16 v[84:99], v[24:27], v[12:15], v[84:99]
    v_exp_f32 v128, v128
    v_exp_f32 v129, v129
    v_exp_f32 v130, v130
    v_exp_f32 v131, v131
    v_cvt_pk_bf16_f32 v42, v128, v129
    v_cvt_pk_bf16_f32 v43, v130, v131
    v_mfma_f32_32x32x16_bf16 v[52:67], v[28:31], v[36:39], v[52:67]
    v_exp_f32 v132, v132
    v_exp_f32 v133, v133
    v_exp_f32 v134, v134
    v_exp_f32 v135, v135
    v_cvt_pk_bf16_f32 v44, v132, v133
    v_cvt_pk_bf16_f32 v45, v134, v135
    v_mfma_f32_32x32x16_bf16 v[100:115], v[24:27], v[16:19], v[100:115]
    ds_read_b128 v[24:27], v160 offset:22528
    v_exp_f32 v136, v136
    v_exp_f32 v137, v137
    v_exp_f32 v138, v138
    v_exp_f32 v139, v139
    v_cvt_pk_bf16_f32 v46, v136, v137
    v_cvt_pk_bf16_f32 v47, v138, v139
    s_waitcnt lgkmcnt(1)
    v_mfma_f32_32x32x16_bf16 v[52:67], v[32:35], v[40:43], v[52:67]
    v_exp_f32 v140, v140
    v_exp_f32 v141, v141
    v_exp_f32 v142, v142
    v_exp_f32 v143, v143
    v_cvt_pk_bf16_f32 v48, v140, v141
    v_cvt_pk_bf16_f32 v49, v142, v143
    v_mfma_f32_32x32x16_bf16 v[68:83], v[28:31], v[44:47], v[68:83]
    ds_read_b128 v[28:31], v162 offset:23616
    v_exp_f32 v144, v144
    v_exp_f32 v145, v145
    v_exp_f32 v146, v146
    v_exp_f32 v147, v147
    v_cvt_pk_bf16_f32 v50, v144, v145
    v_cvt_pk_bf16_f32 v51, v146, v147
    v_mfma_f32_32x32x4bf16_1k v[116:147], v[22:23], v[20:21], 0 cbsz:1 abid:1
    ds_read_b64 v[22:23], v161 offset:26112
    s_setprio 1
    v_exp_f32 v84, v84
    v_exp_f32 v85, v85
    v_exp_f32 v86, v86
    v_exp_f32 v87, v87
    v_cvt_pk_bf16_f32 v36, v84, v85
    v_cvt_pk_bf16_f32 v37, v86, v87
    v_exp_f32 v88, v88
    v_exp_f32 v89, v89
    v_exp_f32 v90, v90
    v_exp_f32 v91, v91
    v_cvt_pk_bf16_f32 v38, v88, v89
    v_cvt_pk_bf16_f32 v39, v90, v91
    v_mfma_f32_32x32x16_bf16 v[68:83], v[32:35], v[48:51], v[68:83]
    ds_read_b128 v[32:35], v162 offset:24320
    v_exp_f32 v92, v92
    v_exp_f32 v93, v93
    v_exp_f32 v94, v94
    v_exp_f32 v95, v95
    v_cvt_pk_bf16_f32 v40, v92, v93
    v_cvt_pk_bf16_f32 v41, v94, v95
    s_waitcnt lgkmcnt(2)
    v_mfma_f32_32x32x16_bf16 v[116:131], v[24:27], v[12:15], v[116:131]
    v_exp_f32 v96, v96
    v_exp_f32 v97, v97
    v_exp_f32 v98, v98
    v_exp_f32 v99, v99
    v_cvt_pk_bf16_f32 v42, v96, v97
    v_cvt_pk_bf16_f32 v43, v98, v99
    v_mfma_f32_32x32x16_bf16 v[52:67], v[28:31], v[36:39], v[52:67]
    v_exp_f32 v100, v100
    v_exp_f32 v101, v101
    v_exp_f32 v102, v102
    v_exp_f32 v103, v103
    v_cvt_pk_bf16_f32 v44, v100, v101
    v_cvt_pk_bf16_f32 v45, v102, v103
    v_mfma_f32_32x32x16_bf16 v[132:147], v[24:27], v[16:19], v[132:147]
    ds_read_b128 v[24:27], v160 offset:24064
    v_exp_f32 v104, v104
    v_exp_f32 v105, v105
    v_exp_f32 v106, v106
    v_exp_f32 v107, v107
    v_cvt_pk_bf16_f32 v46, v104, v105
    v_cvt_pk_bf16_f32 v47, v106, v107
    s_waitcnt lgkmcnt(1)
    v_mfma_f32_32x32x16_bf16 v[52:67], v[32:35], v[40:43], v[52:67]
    v_exp_f32 v108, v108
    v_exp_f32 v109, v109
    v_exp_f32 v110, v110
    v_exp_f32 v111, v111
    v_cvt_pk_bf16_f32 v48, v108, v109
    v_cvt_pk_bf16_f32 v49, v110, v111
    v_mfma_f32_32x32x16_bf16 v[68:83], v[28:31], v[44:47], v[68:83]
    ds_read_b128 v[28:31], v162 offset:25024
    v_exp_f32 v112, v112
    v_exp_f32 v113, v113
    v_exp_f32 v114, v114
    v_exp_f32 v115, v115
    v_cvt_pk_bf16_f32 v50, v112, v113
    v_cvt_pk_bf16_f32 v51, v114, v115
    v_mfma_f32_32x32x4bf16_1k v[84:115], v[22:23], v[20:21], 0 cbsz:1 abid:0
    s_setprio 0
    v_exp_f32 v116, v116
    v_exp_f32 v117, v117
    v_exp_f32 v118, v118
    v_exp_f32 v119, v119
    v_cvt_pk_bf16_f32 v36, v116, v117
    v_cvt_pk_bf16_f32 v37, v118, v119
    v_exp_f32 v120, v120
    v_exp_f32 v121, v121
    v_exp_f32 v122, v122
    v_exp_f32 v123, v123
    v_cvt_pk_bf16_f32 v38, v120, v121
    v_cvt_pk_bf16_f32 v39, v122, v123
    v_mfma_f32_32x32x16_bf16 v[68:83], v[32:35], v[48:51], v[68:83]
    ds_read_b128 v[32:35], v162 offset:25728
    v_exp_f32 v124, v124
    v_exp_f32 v125, v125
    v_exp_f32 v126, v126
    v_exp_f32 v127, v127
    v_cvt_pk_bf16_f32 v40, v124, v125
    v_cvt_pk_bf16_f32 v41, v126, v127
    s_waitcnt lgkmcnt(1)
    v_mfma_f32_32x32x16_bf16 v[84:99], v[24:27], v[12:15], v[84:99]
    v_exp_f32 v128, v128
    v_exp_f32 v129, v129
    v_exp_f32 v130, v130
    v_exp_f32 v131, v131
    v_cvt_pk_bf16_f32 v42, v128, v129
    v_cvt_pk_bf16_f32 v43, v130, v131
    v_mfma_f32_32x32x16_bf16 v[52:67], v[28:31], v[36:39], v[52:67]
    v_exp_f32 v132, v132
    v_exp_f32 v133, v133
    v_exp_f32 v134, v134
    v_exp_f32 v135, v135
    v_cvt_pk_bf16_f32 v44, v132, v133
    v_cvt_pk_bf16_f32 v45, v134, v135
    v_mfma_f32_32x32x16_bf16 v[100:115], v[24:27], v[16:19], v[100:115]
    ds_read_b128 v[24:27], v160 offset:25088
    v_exp_f32 v136, v136
    v_exp_f32 v137, v137
    v_exp_f32 v138, v138
    v_exp_f32 v139, v139
    v_cvt_pk_bf16_f32 v46, v136, v137
    v_cvt_pk_bf16_f32 v47, v138, v139
    s_waitcnt lgkmcnt(1)
    v_mfma_f32_32x32x16_bf16 v[52:67], v[32:35], v[40:43], v[52:67]
    v_exp_f32 v140, v140
    v_exp_f32 v141, v141
    v_exp_f32 v142, v142
    v_exp_f32 v143, v143
    v_cvt_pk_bf16_f32 v48, v140, v141
    v_cvt_pk_bf16_f32 v49, v142, v143
    v_mfma_f32_32x32x16_bf16 v[68:83], v[28:31], v[44:47], v[68:83]
    ds_read_b128 v[28:31], v162 offset:26432
    v_exp_f32 v144, v144
    v_exp_f32 v145, v145
    v_exp_f32 v146, v146
    v_exp_f32 v147, v147
    v_cvt_pk_bf16_f32 v50, v144, v145
    v_cvt_pk_bf16_f32 v51, v146, v147
    s_waitcnt lgkmcnt(0)
    s_barrier
    v_mfma_f32_32x32x4bf16_1k v[116:147], v[22:23], v[20:21], 0 cbsz:1 abid:1
    s_setprio 1
    v_exp_f32 v84, v84
    v_exp_f32 v85, v85
    v_exp_f32 v86, v86
    v_exp_f32 v87, v87
    v_cvt_pk_bf16_f32 v36, v84, v85
    v_cvt_pk_bf16_f32 v37, v86, v87
    v_exp_f32 v88, v88
    v_exp_f32 v89, v89
    v_exp_f32 v90, v90
    v_exp_f32 v91, v91
    v_cvt_pk_bf16_f32 v38, v88, v89
    v_cvt_pk_bf16_f32 v39, v90, v91
    v_mfma_f32_32x32x16_bf16 v[68:83], v[32:35], v[48:51], v[68:83]
    ds_read_b128 v[32:35], v162 offset:43008
    v_exp_f32 v92, v92
    v_exp_f32 v93, v93
    v_exp_f32 v94, v94
    v_exp_f32 v95, v95
    v_cvt_pk_bf16_f32 v40, v92, v93
    v_cvt_pk_bf16_f32 v41, v94, v95
    v_mfma_f32_32x32x16_bf16 v[116:131], v[24:27], v[12:15], v[116:131]
    v_exp_f32 v96, v96
    v_exp_f32 v97, v97
    v_exp_f32 v98, v98
    v_exp_f32 v99, v99
    v_cvt_pk_bf16_f32 v42, v96, v97
    v_cvt_pk_bf16_f32 v43, v98, v99
    v_mfma_f32_32x32x16_bf16 v[52:67], v[28:31], v[36:39], v[52:67]
    v_exp_f32 v100, v100
    v_exp_f32 v101, v101
    v_exp_f32 v102, v102
    v_exp_f32 v103, v103
    v_cvt_pk_bf16_f32 v44, v100, v101
    v_cvt_pk_bf16_f32 v45, v102, v103
    v_mfma_f32_32x32x16_bf16 v[132:147], v[24:27], v[16:19], v[132:147]
    v_exp_f32 v104, v104
    v_exp_f32 v105, v105
    v_exp_f32 v106, v106
    v_exp_f32 v107, v107
    v_cvt_pk_bf16_f32 v46, v104, v105
    v_cvt_pk_bf16_f32 v47, v106, v107
    s_waitcnt lgkmcnt(0)
    v_mfma_f32_32x32x16_bf16 v[52:67], v[32:35], v[40:43], v[52:67]
    v_exp_f32 v108, v108
    v_exp_f32 v109, v109
    v_exp_f32 v110, v110
    v_exp_f32 v111, v111
    v_cvt_pk_bf16_f32 v48, v108, v109
    v_cvt_pk_bf16_f32 v49, v110, v111
    v_mfma_f32_32x32x16_bf16 v[68:83], v[28:31], v[44:47], v[68:83]
    ds_read_b128 v[28:31], v162 offset:43712
    v_exp_f32 v112, v112
    v_exp_f32 v113, v113
    v_exp_f32 v114, v114
    v_exp_f32 v115, v115
    v_cvt_pk_bf16_f32 v50, v112, v113
    v_cvt_pk_bf16_f32 v51, v114, v115
    s_setprio 0
    v_exp_f32 v116, v116
    v_exp_f32 v117, v117
    v_exp_f32 v118, v118
    v_exp_f32 v119, v119
    v_cvt_pk_bf16_f32 v36, v116, v117
    v_cvt_pk_bf16_f32 v37, v118, v119
    v_exp_f32 v120, v120
    v_exp_f32 v121, v121
    v_exp_f32 v122, v122
    v_exp_f32 v123, v123
    v_cvt_pk_bf16_f32 v38, v120, v121
    v_cvt_pk_bf16_f32 v39, v122, v123
    v_mfma_f32_32x32x16_bf16 v[68:83], v[32:35], v[48:51], v[68:83]
    ds_read_b128 v[32:35], v162 offset:44416
    v_exp_f32 v124, v124
    v_exp_f32 v125, v125
    v_exp_f32 v126, v126
    v_exp_f32 v127, v127
    v_cvt_pk_bf16_f32 v40, v124, v125
    v_cvt_pk_bf16_f32 v41, v126, v127
    v_exp_f32 v128, v128
    v_exp_f32 v129, v129
    v_exp_f32 v130, v130
    v_exp_f32 v131, v131
    v_cvt_pk_bf16_f32 v42, v128, v129
    v_cvt_pk_bf16_f32 v43, v130, v131
    s_waitcnt lgkmcnt(1)
    v_mfma_f32_32x32x16_bf16 v[52:67], v[28:31], v[36:39], v[52:67]
    v_exp_f32 v132, v132
    v_exp_f32 v133, v133
    v_exp_f32 v134, v134
    v_exp_f32 v135, v135
    v_cvt_pk_bf16_f32 v44, v132, v133
    v_cvt_pk_bf16_f32 v45, v134, v135
    v_exp_f32 v136, v136
    v_exp_f32 v137, v137
    v_exp_f32 v138, v138
    v_exp_f32 v139, v139
    v_cvt_pk_bf16_f32 v46, v136, v137
    v_cvt_pk_bf16_f32 v47, v138, v139
    s_waitcnt lgkmcnt(0)
    v_mfma_f32_32x32x16_bf16 v[52:67], v[32:35], v[40:43], v[52:67]
    v_exp_f32 v140, v140
    v_exp_f32 v141, v141
    v_exp_f32 v142, v142
    v_exp_f32 v143, v143
    v_cvt_pk_bf16_f32 v48, v140, v141
    v_cvt_pk_bf16_f32 v49, v142, v143
    v_mfma_f32_32x32x16_bf16 v[68:83], v[28:31], v[44:47], v[68:83]
    v_exp_f32 v144, v144
    v_exp_f32 v145, v145
    v_exp_f32 v146, v146
    v_exp_f32 v147, v147
    v_cvt_pk_bf16_f32 v50, v144, v145
    v_cvt_pk_bf16_f32 v51, v146, v147
    s_nop 1
    v_mfma_f32_32x32x16_bf16 v[68:83], v[32:35], v[48:51], v[68:83]
    ds_write_b128 v157, v[52:55] offset:0
    ds_write_b128 v157, v[56:59] offset:1024
    ds_write_b128 v157, v[60:63] offset:2048
    s_waitcnt lgkmcnt(0)
    s_barrier
    ds_read_b128 v[84:87], v158 offset:0
    ds_read_b128 v[88:91], v158 offset:1024
    ds_read_b128 v[92:95], v158 offset:2048
    s_mov_b32 s60, 0x33800000
    s_mov_b32 s61, 0x67800000
    s_mov_b32 s44, 0x7f800000
    s_waitcnt lgkmcnt(0)
    v_add_f32 v68, v68, v84
    v_add_f32 v69, v69, v85
    v_add_f32 v70, v70, v86
    v_add_f32 v71, v71, v87
    v_add_f32 v72, v72, v88
    v_add_f32 v73, v73, v89
    v_add_f32 v74, v74, v90
    v_add_f32 v75, v75, v91
    v_add_f32 v76, v76, v92
    v_add_f32 v77, v77, v93
    v_add_f32 v78, v78, v94
    v_add_f32 v79, v79, v95
    v_mov_b32 v9, v76
    v_mov_b32 v10, v76
    v_max3_f32 v11, abs(v68), abs(v69), abs(v70)
    v_max3_f32 v11, v11, abs(v71), abs(v72)
    v_permlane32_swap_b32 v9, v10
    v_max3_f32 v11, v11, abs(v73), abs(v74)
    v_max3_f32 v11, v11, abs(v75), abs(v76)
    v_max3_f32 v11, v11, abs(v77), abs(v78)
    v_max_f32_e64 v11, v11, abs(v79)
    v_cmp_le_f32 vcc, s60, v10
    v_cmp_ge_f32 s[92:93], s61, v10
    v_cmp_gt_f32 s[94:95], s44, v11
    s_and_b64 vcc, vcc, s[92:93]
    s_and_b64 vcc, vcc, s[94:95]
    s_cmp_eq_u64 vcc, -1
    s_cbranch_scc0 Lfb_65
Lfin_66:
    v_rcp_f32 v10, v10
    s_nop 0
    v_mul_f32 v68, v68, v10
    v_mul_f32 v69, v69, v10
    v_mul_f32 v70, v70, v10
    v_mul_f32 v71, v71, v10
    v_mul_f32 v72, v72, v10
    v_mul_f32 v73, v73, v10
    v_mul_f32 v74, v74, v10
    v_mul_f32 v75, v75, v10
    v_cvt_pk_bf16_f32 v36, v68, v69
    v_cvt_pk_bf16_f32 v37, v70, v71
    v_cvt_pk_bf16_f32 v38, v72, v73
    v_cvt_pk_bf16_f32 v39, v74, v75
    buffer_store_dwordx4 v[36:39], v2, s[32:35], s62 offen sc1
    v_mul_f32 v76, v76, v10
    v_mul_f32 v77, v77, v10
    v_mul_f32 v78, v78, v10
    v_mul_f32 v79, v79, v10
    v_cvt_pk_bf16_f32 v40, v76, v77
    v_cvt_pk_bf16_f32 v41, v78, v79
    s_mov_b32 exec_hi, 0
    buffer_store_dwordx2 v[40:41], v3, s[32:35], s63 offen sc1
    s_mov_b64 exec, -1
    v_mov_b32 v9, 102416
    v_mov_b32 v10, 1
    s_mov_b64 exec, 1
    s_waitcnt vmcnt(0)
    ds_add_rtn_u32 v10, v9, v10
    s_waitcnt lgkmcnt(0)
    v_readfirstlane_b32 s60, v10
    s_mov_b64 exec, -1
    s_mov_b32 s67, s60
    s_cmp_lg_u32 s60, 7
    s_cbranch_scc1 Lnolast_69
    s_lshl_b32 s60, s23, 7
    s_add_u32 s60, s60, 13893632
    v_lshlrev_b32 v9, 12, v1
    v_mov_b32 v10, s66
    s_mov_b64 exec, 1
    buffer_store_dword v10, v9, s[32:35], s60 offen sc1
    s_mov_b64 exec, -1
Lnolast_69:
    s_mov_b32 s36, s40
    s_mov_b32 s37, s41
    s_mov_b32 s38, 5242880
    s_mov_b32 s39, 0x20000
    v_and_b32 v2, 15, v1
    v_lshrrev_b32 v3, 4, v1
    s_lshr_b32 s68, s22, 2
    s_and_b32 s48, s22, 3
    s_lshl_b32 s60, s65, 2
    s_add_u32 s48, s48, s60
    s_mul_i32 s61, s68, 1356800
    s_add_u32 s61, s61, 2097152
    s_lshl_b32 s60, s48, 8
    s_add_u32 s54, s61, s60
    v_lshrrev_b32 v6, 2, v2
    v_and_b32 v8, 3, v2
    v_lshlrev_b32 v4, 3, v3
    v_mul_u32_u24 v6, 160, v6
    v_lshl_add_u32 v6, v8, 3, v6
    s_mul_i32 s60, s68, 51200
    v_add_u32 v6, s60, v6
    s_mov_b32 s61, 100991232
    v_bfe_u32 v7, s61, v4, 8
    v_mul_u32_u24 v7, 640, v7
    v_add_u32 v152, v7, v6
    s_mov_b32 s61, 134677250
    v_bfe_u32 v7, s61, v4, 8
    v_mul_u32_u24 v7, 640, v7
    v_add_u32 v153, v7, v6
    s_mov_b32 s61, 269421322
    v_bfe_u32 v7, s61, v4, 8
    v_mul_u32_u24 v7, 640, v7
    v_add_u32 v154, v7, v6
    s_mov_b32 s61, 303107340
    v_bfe_u32 v7, s61, v4, 8
    v_mul_u32_u24 v7, 640, v7
    v_add_u32 v155, v7, v6
    s_mov_b32 s61, 353637124
    v_bfe_u32 v7, s61, v4, 8
    v_mul_u32_u24 v7, 640, v7
    v_add_u32 v156, v7, v6
    s_mov_b32 s61, 387321353
    v_bfe_u32 v7, s61, v4, 8
    v_mul_u32_u24 v7, 640, v7
    v_add_u32 v157, v7, v6
    s_mov_b32 s61, 522066457
    v_bfe_u32 v7, s61, v4, 8
    v_mul_u32_u24 v7, 640, v7
    v_add_u32 v158, v7, v6
    s_mov_b32 s61, 555752475
    v_bfe_u32 v7, s61, v4, 8
    v_mul_u32_u24 v7, 640, v7
    v_add_u32 v159, v7, v6
    s_mov_b32 s61, 655893539
    v_bfe_u32 v7, s61, v4, 8
    v_mul_u32_u24 v7, 640, v7
    v_add_u32 v160, v7, v6
    s_mov_b32 s61, 572335653
    v_bfe_u32 v7, s61, v4, 8
    v_mul_u32_u24 v7, 640, v7
    v_add_u32 v161, v7, v6
    v_mul_u32_u24 v4, 33920, v3
    v_lshl_add_u32 v4, v2, 4, v4
    ds_read_b64_tr_b16 v[72:73], v152 offset:0
    ds_read_b64_tr_b16 v[74:75], v153 offset:0
    ds_read_b64_tr_b16 v[76:77], v152 offset:32
    ds_read_b64_tr_b16 v[78:79], v153 offset:32
    ds_read_b64_tr_b16 v[80:81], v152 offset:64
    ds_read_b64_tr_b16 v[82:83], v153 offset:64
    ds_read_b64_tr_b16 v[84:85], v152 offset:96
    ds_read_b64_tr_b16 v[86:87], v153 offset:96
    ds_read_b64_tr_b16 v[88:89], v152 offset:128
    ds_read_b64_tr_b16 v[90:91], v153 offset:128
    ds_read_b64_tr_b16 v[92:93], v154 offset:0
    ds_read_b64_tr_b16 v[94:95], v155 offset:0
    ds_read_b64_tr_b16 v[96:97], v154 offset:32
    ds_read_b64_tr_b16 v[98:99], v155 offset:32
    ds_read_b64_tr_b16 v[100:101], v154 offset:64
    ds_read_b64_tr_b16 v[102:103], v155 offset:64
    ds_read_b64_tr_b16 v[104:105], v154 offset:96
    ds_read_b64_tr_b16 v[106:107], v155 offset:96
    ds_read_b64_tr_b16 v[108:109], v154 offset:128
    ds_read_b64_tr_b16 v[110:111], v155 offset:128
    ds_read_b64_tr_b16 v[112:113], v156 offset:0
    ds_read_b64_tr_b16 v[114:115], v157 offset:0
    ds_read_b64_tr_b16 v[116:117], v156 offset:32
    ds_read_b64_tr_b16 v[118:119], v157 offset:32
    ds_read_b64_tr_b16 v[120:121], v156 offset:64
    ds_read_b64_tr_b16 v[122:123], v157 offset:64
    ds_read_b64_tr_b16 v[124:125], v156 offset:96
    ds_read_b64_tr_b16 v[126:127], v157 offset:96
    ds_read_b64_tr_b16 v[128:129], v156 offset:128
    ds_read_b64_tr_b16 v[130:131], v157 offset:128
    ds_read_b64_tr_b16 v[132:133], v158 offset:0
    ds_read_b64_tr_b16 v[134:135], v159 offset:0
    ds_read_b64_tr_b16 v[136:137], v158 offset:32
    ds_read_b64_tr_b16 v[138:139], v159 offset:32
    ds_read_b64_tr_b16 v[140:141], v158 offset:64
    ds_read_b64_tr_b16 v[142:143], v159 offset:64
    ds_read_b64_tr_b16 v[144:145], v158 offset:96
    ds_read_b64_tr_b16 v[146:147], v159 offset:96
    ds_read_b64_tr_b16 v[148:149], v158 offset:128
    ds_read_b64_tr_b16 v[150:151], v159 offset:128
    s_and_b32 s60, s22, 3
    s_lshl_b32 s61, s60, 2
    s_add_u32 s61, s61, 102400
    v_mov_b32 v166, s61
    s_lshl_b32 s61, s60, 11
    s_add_u32 s61, s61, 149504
    v_add_u32 v162, s61, v5
    s_mul_i32 s60, s60, 3072
    s_add_u32 s60, s60, 130048
    v_add_u32 v163, s60, v5
    s_and_b32 s68, s22, 3
    s_mul_i32 s60, s68, 3072
    s_add_u32 s60, s60, 117760
    v_mul_u32_u24 v164, 176, v2
    v_lshl_add_u32 v164, v3, 3, v164
    v_add_u32 v164, s60, v164
    v_add_u32 v10, 0, v1
    v_mul_u32_u24 v11, 6554, v10
    v_lshrrev_b32 v11, 16, v11
    v_mul_u32_u24 v9, 10, v11
    v_sub_u32 v10, v10, v9
    v_lshlrev_b32 v10, 4, v10
    v_mul_u32_u24 v9, 176, v11
    v_add3_u32 v2, v9, v10, s60
    v_mul_u32_u24 v9, 2560, v11
    v_add_u32 v6, v9, v10
    v_add_u32 v10, 64, v1
    v_mul_u32_u24 v11, 6554, v10
    v_lshrrev_b32 v11, 16, v11
    v_mul_u32_u24 v9, 10, v11
    v_sub_u32 v10, v10, v9
    v_lshlrev_b32 v10, 4, v10
    v_mul_u32_u24 v9, 176, v11
    v_add3_u32 v3, v9, v10, s60
    v_mul_u32_u24 v9, 2560, v11
    v_add_u32 v7, v9, v10
    v_add_u32 v10, 128, v1
    v_mul_u32_u24 v11, 6554, v10
    v_lshrrev_b32 v11, 16, v11
    v_mul_u32_u24 v9, 10, v11
    v_sub_u32 v10, v10, v9
    v_lshlrev_b32 v10, 4, v10
    v_mul_u32_u24 v9, 176, v11
    v_add3_u32 v165, v9, v10, s60
    v_mul_u32_u24 v9, 2560, v11
    v_add_u32 v167, v9, v10
    s_mul_i32 s48, s48, 40960
    s_mul_i32 s61, s64, 160
    s_add_u32 s48, s48, s61
    v_mov_b32 v5, v166
    v_mov_b32 v8, 102420
    s_cmp_lg_u32 s67, 0
    s_cbranch_scc1 Lnofirst_70
    v_and_b32 v12, 7, v1
    v_lshlrev_b32 v12, 7, v12
    s_lshl_b32 s69, s65, 10
    s_add_u32 s69, s69, 13893632
    s_mov_b64 exec, 255
    s_mov_b32 s44, 400000
Lpoll_71:
    buffer_load_dword v13, v12, s[32:35], s69 offen sc1
Lpck_73:
    s_waitcnt vmcnt(0)
    v_xor_b32 v13, s66, v13
    v_cmp_ne_u32 vcc, 0, v13
    s_nop 1
    s_cmp_lg_u64 vcc, 0
    s_cbranch_scc0 Lpok_72
    s_sub_u32 s44, s44, 1
    s_cbranch_scc0 Lpoll_71
Lpok_72:
    s_mov_b64 exec, -1
    ds_write_b32 v8, v8
Lnofirst_70:
    s_mov_b32 s44, 6400000
Lgw_74:
    ds_read_b32 v13, v8
    s_sub_u32 s44, s44, 1
    s_cbranch_scc1 Lgo_75
    s_waitcnt lgkmcnt(0)
    v_readfirstlane_b32 s60, v13
    s_cmp_eq_u32 s60, 0
    s_cbranch_scc1 Lgw_74
Lgo_75:
    s_waitcnt lgkmcnt(0)
    s_mov_b32 s61, s54
    buffer_load_dwordx4 v[12:15], v4, s[32:35], s61 offen sc1
    s_add_u32 s61, s61, 135680
    buffer_load_dwordx4 v[16:19], v4, s[32:35], s61 offen sc1
    s_add_u32 s61, s61, 135680
    buffer_load_dwordx4 v[20:23], v4, s[32:35], s61 offen sc1
    s_add_u32 s61, s61, 135680
    buffer_load_dwordx4 v[24:27], v4, s[32:35], s61 offen sc1
    s_add_u32 s61, s61, 135680
    buffer_load_dwordx4 v[28:31], v4, s[32:35], s61 offen sc1
    s_add_u32 s61, s61, 135680
    buffer_load_dwordx4 v[32:35], v4, s[32:35], s61 offen sc1
    s_add_u32 s61, s61, 135680
    buffer_load_dwordx4 v[36:39], v4, s[32:35], s61 offen sc1
    s_add_u32 s61, s61, 135680
    buffer_load_dwordx4 v[40:43], v4, s[32:35], s61 offen sc1
    s_add_u32 s61, s61, 135680
    buffer_load_dwordx4 v[44:47], v4, s[32:35], s61 offen sc1
    s_add_u32 s61, s61, 135680
    buffer_load_dwordx4 v[48:51], v4, s[32:35], s61 offen sc1
    s_add_u32 s61, s61, 135680
    s_cmp_lt_u32 s22, 4
    s_cbranch_scc1 Llop_76
    s_setprio 1
Llop_76:
    s_waitcnt vmcnt(9) lgkmcnt(0)
    v_mfma_f32_16x16x32_bf16 v[52:55], v[72:75], v[12:15], 0
    ds_read_b64_tr_b16 v[72:73], v160 offset:0
    ds_read_b64_tr_b16 v[74:75], v161 offset:0
    v_mfma_f32_16x16x32_bf16 v[56:59], v[76:79], v[12:15], 0
    ds_read_b64_tr_b16 v[76:77], v160 offset:32
    ds_read_b64_tr_b16 v[78:79], v161 offset:32
    v_mfma_f32_16x16x32_bf16 v[60:63], v[80:83], v[12:15], 0
    ds_read_b64_tr_b16 v[80:81], v160 offset:64
    ds_read_b64_tr_b16 v[82:83], v161 offset:64
    v_mfma_f32_16x16x32_bf16 v[64:67], v[84:87], v[12:15], 0
    ds_read_b64_tr_b16 v[84:85], v160 offset:96
    ds_read_b64_tr_b16 v[86:87], v161 offset:96
    v_mfma_f32_16x16x32_bf16 v[68:71], v[88:91], v[12:15], 0
    ds_read_b64_tr_b16 v[88:89], v160 offset:128
    ds_read_b64_tr_b16 v[90:91], v161 offset:128
    s_waitcnt vmcnt(8) lgkmcnt(10)
    v_mfma_f32_16x16x32_bf16 v[52:55], v[92:95], v[16:19], v[52:55]
    ds_read_b64_tr_b16 v[92:93], v152 offset:25600
    ds_read_b64_tr_b16 v[94:95], v153 offset:25600
    v_mfma_f32_16x16x32_bf16 v[56:59], v[96:99], v[16:19], v[56:59]
    ds_read_b64_tr_b16 v[96:97], v152 offset:25632
    ds_read_b64_tr_b16 v[98:99], v153 offset:25632
    v_mfma_f32_16x16x32_bf16 v[60:63], v[100:103], v[16:19], v[60:63]
    ds_read_b64_tr_b16 v[100:101], v152 offset:25664
    ds_read_b64_tr_b16 v[102:103], v153 offset:25664
    v_mfma_f32_16x16x32_bf16 v[64:67], v[104:107], v[16:19], v[64:67]
    ds_read_b64_tr_b16 v[104:105], v152 offset:25696
    ds_read_b64_tr_b16 v[106:107], v153 offset:25696
    v_mfma_f32_16x16x32_bf16 v[68:71], v[108:111], v[16:19], v[68:71]
    ds_read_b64_tr_b16 v[108:109], v152 offset:25728
    ds_read_b64_tr_b16 v[110:111], v153 offset:25728
    s_waitcnt vmcnt(7) lgkmcnt(15)
    v_mfma_f32_16x16x32_bf16 v[52:55], v[112:115], v[20:23], v[52:55]
    ds_read_b64_tr_b16 v[112:113], v154 offset:25600
    ds_read_b64_tr_b16 v[114:115], v155 offset:25600
    v_mfma_f32_16x16x32_bf16 v[56:59], v[116:119], v[20:23], v[56:59]
    ds_read_b64_tr_b16 v[116:117], v154 offset:25632
    ds_read_b64_tr_b16 v[118:119], v155 offset:25632
    v_mfma_f32_16x16x32_bf16 v[60:63], v[120:123], v[20:23], v[60:63]
    ds_read_b64_tr_b16 v[120:121], v154 offset:25664
    ds_read_b64_tr_b16 v[122:123], v155 offset:25664
    v_mfma_f32_16x16x32_bf16 v[64:67], v[124:127], v[20:23], v[64:67]
    ds_read_b64_tr_b16 v[124:125], v154 offset:25696
    ds_read_b64_tr_b16 v[126:127], v155 offset:25696
    v_mfma_f32_16x16x32_bf16 v[68:71], v[128:131], v[20:23], v[68:71]
    ds_read_b64_tr_b16 v[128:129], v154 offset:25728
    ds_read_b64_tr_b16 v[130:131], v155 offset:25728
    s_waitcnt vmcnt(6) lgkmcnt(15)
    v_mfma_f32_16x16x32_bf16 v[52:55], v[132:135], v[24:27], v[52:55]
    ds_read_b64_tr_b16 v[132:133], v156 offset:25600
    ds_read_b64_tr_b16 v[134:135], v157 offset:25600
    v_mfma_f32_16x16x32_bf16 v[56:59], v[136:139], v[24:27], v[56:59]
    ds_read_b64_tr_b16 v[136:137], v156 offset:25632
    ds_read_b64_tr_b16 v[138:139], v157 offset:25632
    v_mfma_f32_16x16x32_bf16 v[60:63], v[140:143], v[24:27], v[60:63]
    ds_read_b64_tr_b16 v[140:141], v156 offset:25664
    ds_read_b64_tr_b16 v[142:143], v157 offset:25664
    v_mfma_f32_16x16x32_bf16 v[64:67], v[144:147], v[24:27], v[64:67]
    ds_read_b64_tr_b16 v[144:145], v156 offset:25696
    ds_read_b64_tr_b16 v[146:147], v157 offset:25696
    v_mfma_f32_16x16x32_bf16 v[68:71], v[148:151], v[24:27], v[68:71]
    ds_read_b64_tr_b16 v[148:149], v156 offset:25728
    ds_read_b64_tr_b16 v[150:151], v157 offset:25728
    s_waitcnt vmcnt(5) lgkmcnt(15)
    v_mfma_f32_16x16x32_bf16 v[52:55], v[72:75], v[28:31], v[52:55]
    ds_read_b64_tr_b16 v[72:73], v158 offset:25600
    ds_read_b64_tr_b16 v[74:75], v159 offset:25600
    v_mfma_f32_16x16x32_bf16 v[56:59], v[76:79], v[28:31], v[56:59]
    ds_read_b64_tr_b16 v[76:77], v158 offset:25632
    ds_read_b64_tr_b16 v[78:79], v159 offset:25632
    v_mfma_f32_16x16x32_bf16 v[60:63], v[80:83], v[28:31], v[60:63]
    ds_read_b64_tr_b16 v[80:81], v158 offset:25664
    ds_read_b64_tr_b16 v[82:83], v159 offset:25664
    v_mfma_f32_16x16x32_bf16 v[64:67], v[84:87], v[28:31], v[64:67]
    ds_read_b64_tr_b16 v[84:85], v158 offset:25696
    ds_read_b64_tr_b16 v[86:87], v159 offset:25696
    v_mfma_f32_16x16x32_bf16 v[68:71], v[88:91], v[28:31], v[68:71]
    ds_read_b64_tr_b16 v[88:89], v158 offset:25728
    ds_read_b64_tr_b16 v[90:91], v159 offset:25728
    s_waitcnt vmcnt(4) lgkmcnt(15)
    v_mfma_f32_16x16x32_bf16 v[52:55], v[92:95], v[32:35], v[52:55]
    ds_read_b64_tr_b16 v[92:93], v160 offset:25600
    ds_read_b64_tr_b16 v[94:95], v161 offset:25600
    v_mfma_f32_16x16x32_bf16 v[56:59], v[96:99], v[32:35], v[56:59]
    ds_read_b64_tr_b16 v[96:97], v160 offset:25632
    ds_read_b64_tr_b16 v[98:99], v161 offset:25632
    v_mfma_f32_16x16x32_bf16 v[60:63], v[100:103], v[32:35], v[60:63]
    ds_read_b64_tr_b16 v[100:101], v160 offset:25664
    ds_read_b64_tr_b16 v[102:103], v161 offset:25664
    v_mfma_f32_16x16x32_bf16 v[64:67], v[104:107], v[32:35], v[64:67]
    ds_read_b64_tr_b16 v[104:105], v160 offset:25696
    ds_read_b64_tr_b16 v[106:107], v161 offset:25696
    v_mfma_f32_16x16x32_bf16 v[68:71], v[108:111], v[32:35], v[68:71]
    ds_read_b64_tr_b16 v[108:109], v160 offset:25728
    ds_read_b64_tr_b16 v[110:111], v161 offset:25728
    s_waitcnt vmcnt(3) lgkmcnt(15)
    v_mfma_f32_16x16x32_bf16 v[52:55], v[112:115], v[36:39], v[52:55]
    v_mfma_f32_16x16x32_bf16 v[56:59], v[116:119], v[36:39], v[56:59]
    v_mfma_f32_16x16x32_bf16 v[60:63], v[120:123], v[36:39], v[60:63]
    v_mfma_f32_16x16x32_bf16 v[64:67], v[124:127], v[36:39], v[64:67]
    v_mfma_f32_16x16x32_bf16 v[68:71], v[128:131], v[36:39], v[68:71]
    s_waitcnt vmcnt(2) lgkmcnt(15)
    v_mfma_f32_16x16x32_bf16 v[52:55], v[132:135], v[40:43], v[52:55]
    v_mfma_f32_16x16x32_bf16 v[56:59], v[136:139], v[40:43], v[56:59]
    v_mfma_f32_16x16x32_bf16 v[60:63], v[140:143], v[40:43], v[60:63]
    v_mfma_f32_16x16x32_bf16 v[64:67], v[144:147], v[40:43], v[64:67]
    v_mfma_f32_16x16x32_bf16 v[68:71], v[148:151], v[40:43], v[68:71]
    s_waitcnt vmcnt(1) lgkmcnt(10)
    v_mfma_f32_16x16x32_bf16 v[52:55], v[72:75], v[44:47], v[52:55]
    v_mfma_f32_16x16x32_bf16 v[56:59], v[76:79], v[44:47], v[56:59]
    v_mfma_f32_16x16x32_bf16 v[60:63], v[80:83], v[44:47], v[60:63]
    v_mfma_f32_16x16x32_bf16 v[64:67], v[84:87], v[44:47], v[64:67]
    v_mfma_f32_16x16x32_bf16 v[68:71], v[88:91], v[44:47], v[68:71]
    s_waitcnt vmcnt(0) lgkmcnt(0)
    v_mfma_f32_16x16x32_bf16 v[52:55], v[92:95], v[48:51], v[52:55]
    v_mfma_f32_16x16x32_bf16 v[56:59], v[96:99], v[48:51], v[56:59]
    v_mfma_f32_16x16x32_bf16 v[60:63], v[100:103], v[48:51], v[60:63]
    v_mfma_f32_16x16x32_bf16 v[64:67], v[104:107], v[48:51], v[64:67]
    v_mfma_f32_16x16x32_bf16 v[68:71], v[108:111], v[48:51], v[68:71]
    ds_read_b32 v9, v5
    ds_read_b128 v[112:115], v163 offset:0
    ds_read_b128 v[116:119], v163 offset:1024
    ds_read_b128 v[120:123], v163 offset:2048
    ds_read_b128 v[124:127], v162 offset:3072
    ds_read_b128 v[128:131], v162 offset:4096
    s_cmp_lt_u32 s22, 4
    s_cbranch_scc1 Lup_77
    s_nop 5
    ds_write_b128 v163, v[52:55] offset:0
    ds_write_b128 v163, v[56:59] offset:1024
    ds_write_b128 v163, v[60:63] offset:2048
    ds_write_b128 v162, v[64:67] offset:3072
    ds_write_b128 v162, v[68:71] offset:4096
    ds_write_b32 v5, v5
    s_endpgm
Lup_77:
    s_mov_b32 s44, 6400000
Ljw_79:
    s_waitcnt lgkmcnt(5)
    v_readfirstlane_b32 s61, v9
    s_sub_u32 s44, s44, 1
    s_cbranch_scc1 Lgot_78
    s_cmp_lg_u32 s61, 0
    s_cbranch_scc1 Lgot_78
    s_waitcnt lgkmcnt(0)
    ds_read_b32 v9, v5
    ds_read_b128 v[112:115], v163 offset:0
    ds_read_b128 v[116:119], v163 offset:1024
    ds_read_b128 v[120:123], v163 offset:2048
    ds_read_b128 v[124:127], v162 offset:3072
    ds_read_b128 v[128:131], v162 offset:4096
    s_branch Ljw_79
Lgot_78:
    s_waitcnt lgkmcnt(4)
    v_add_f32 v52, v52, v112
    v_add_f32 v53, v53, v113
    v_add_f32 v54, v54, v114
    v_add_f32 v55, v55, v115
    s_waitcnt lgkmcnt(3)
    v_add_f32 v56, v56, v116
    v_add_f32 v57, v57, v117
    v_add_f32 v58, v58, v118
    v_add_f32 v59, v59, v119
    s_waitcnt lgkmcnt(2)
    v_add_f32 v60, v60, v120
    v_add_f32 v61, v61, v121
    v_add_f32 v62, v62, v122
    v_add_f32 v63, v63, v123
    s_waitcnt lgkmcnt(1)
    v_add_f32 v64, v64, v124
    v_add_f32 v65, v65, v125
    v_add_f32 v66, v66, v126
    v_add_f32 v67, v67, v127
    s_waitcnt lgkmcnt(0)
    v_add_f32 v68, v68, v128
    v_add_f32 v69, v69, v129
    v_add_f32 v70, v70, v130
    v_add_f32 v71, v71, v131
    v_cvt_pk_bf16_f32 v72, v52, v53
    v_cvt_pk_bf16_f32 v73, v54, v55
    ds_write_b64 v164, v[72:73] offset:0
    v_cvt_pk_bf16_f32 v74, v56, v57
    v_cvt_pk_bf16_f32 v75, v58, v59
    ds_write_b64 v164, v[74:75] offset:32
    v_cvt_pk_bf16_f32 v76, v60, v61
    v_cvt_pk_bf16_f32 v77, v62, v63
    ds_write_b64 v164, v[76:77] offset:64
    v_cvt_pk_bf16_f32 v78, v64, v65
    v_cvt_pk_bf16_f32 v79, v66, v67
    ds_write_b64 v164, v[78:79] offset:96
    v_cvt_pk_bf16_f32 v80, v68, v69
    v_cvt_pk_bf16_f32 v81, v70, v71
    ds_write_b64 v164, v[80:81] offset:128
    ds_read_b128 v[84:87], v2
    ds_read_b128 v[88:91], v3
    s_mov_b32 exec_hi, 0
    ds_read_b128 v[92:95], v165
    s_mov_b32 exec_hi, -1
    s_waitcnt lgkmcnt(2)
    buffer_store_dwordx4 v[84:87], v6, s[36:39], s48 offen nt
    s_waitcnt lgkmcnt(1)
    buffer_store_dwordx4 v[88:91], v7, s[36:39], s48 offen nt
    s_mov_b32 exec_hi, 0
    s_waitcnt lgkmcnt(0)
    buffer_store_dwordx4 v[92:95], v167, s[36:39], s48 offen nt
Ldone_67:
    s_endpgm
Lfb_65:
    s_mov_b32 exec_hi, 0
    v_mov_b32 v20, 0
    v_mov_b32 v21, 0
    s_mov_b64 exec, -1
    v_and_b32 v140, 31, v1
    v_min_u32 v141, 20, v140
    v_lshlrev_b32 v140, 3, v140
    v_lshrrev_b32 v9, 5, v1
    v_mul_u32_u24 v9, 352, v9
    v_lshl_add_u32 v141, v141, 4, v9
    v_mov_b32 v11, 0xff800000
    s_mov_b32 s44, 0
Lmax_80:
    s_lshl_b32 s69, s44, 1
    s_bfe_u32 s60, s69, 0x30003
    s_mul_i32 s60, s60, 21504
    s_lshr_b32 s61, s69, 6
    s_lshl_b32 s61, s61, 1
    s_bfe_u32 s68, s69, 0x10002
    s_add_u32 s61, s61, s68
    s_mul_i32 s61, s61, 2560
    s_add_u32 s60, s60, s61
    s_add_u32 s60, s60, 13500416
    s_and_b32 s61, s44, 1
    s_lshl_b32 s68, s61, 10
    s_add_u32 s68, s68, s60
    s_lshl_b32 s61, s61, 8
    s_add_u32 s61, s61, s60
    buffer_load_dwordx4 v[24:27], v5, s[32:35], s68 offen sc1
    buffer_load_dwordx2 v[22:23], v140, s[32:35], s61 offen offset:2048 sc1
    s_waitcnt vmcnt(0)
    v_mfma_f32_32x32x16_bf16 v[84:99], v[24:27], v[16:19], 0
    v_mfma_f32_32x32x8_bf16 v[84:99], v[22:23], v[20:21], v[84:99]
    s_nop 11
    v_max3_f32 v11, v11, v84, v85
    v_max3_f32 v11, v11, v86, v87
    v_max3_f32 v11, v11, v88, v89
    v_max3_f32 v11, v11, v90, v91
    v_max3_f32 v11, v11, v92, v93
    v_max3_f32 v11, v11, v94, v95
    v_max3_f32 v11, v11, v96, v97
    v_max3_f32 v11, v11, v98, v99
    s_add_u32 s44, s44, 1
    s_cmp_lt_u32 s44, 64
    s_cbranch_scc1 Lmax_80
    v_mov_b32 v9, v11
    s_nop 1
    v_permlane32_swap_b32 v9, v11
    s_nop 1
    v_max_f32 v11, v11, v9
    v_sub_f32 v116, 0, v11
    v_mov_b32 v68, 0
    v_sub_f32 v117, 0, v11
    v_mov_b32 v69, 0
    v_sub_f32 v118, 0, v11
    v_mov_b32 v70, 0
    v_sub_f32 v119, 0, v11
    v_mov_b32 v71, 0
    v_sub_f32 v120, 0, v11
    v_mov_b32 v72, 0
    v_sub_f32 v121, 0, v11
    v_mov_b32 v73, 0
    v_sub_f32 v122, 0, v11
    v_mov_b32 v74, 0
    v_sub_f32 v123, 0, v11
    v_mov_b32 v75, 0
    v_sub_f32 v124, 0, v11
    v_mov_b32 v76, 0
    v_sub_f32 v125, 0, v11
    v_mov_b32 v77, 0
    v_sub_f32 v126, 0, v11
    v_mov_b32 v78, 0
    v_sub_f32 v127, 0, v11
    v_mov_b32 v79, 0
    v_sub_f32 v128, 0, v11
    v_mov_b32 v80, 0
    v_sub_f32 v129, 0, v11
    v_mov_b32 v81, 0
    v_sub_f32 v130, 0, v11
    v_mov_b32 v82, 0
    v_sub_f32 v131, 0, v11
    v_mov_b32 v83, 0
    s_mov_b32 s44, 0
Lsafe_81:
    s_lshl_b32 s69, s44, 1
    s_bfe_u32 s60, s69, 0x30003
    s_mul_i32 s60, s60, 21504
    s_lshr_b32 s61, s69, 6
    s_lshl_b32 s61, s61, 1
    s_bfe_u32 s68, s69, 0x10002
    s_add_u32 s61, s61, s68
    s_mul_i32 s61, s61, 2560
    s_add_u32 s60, s60, s61
    s_add_u32 s60, s60, 13500416
    s_and_b32 s61, s44, 1
    s_lshl_b32 s68, s61, 10
    s_add_u32 s68, s68, s60
    s_lshl_b32 s61, s61, 8
    s_add_u32 s61, s61, s60
    buffer_load_dwordx4 v[24:27], v5, s[32:35], s68 offen sc1
    buffer_load_dwordx2 v[22:23], v140, s[32:35], s61 offen offset:2048 sc1
    s_and_b32 s61, s69, 63
    s_add_u32 s61, s61, 3
    s_lshr_b32 s60, s61, 3
    s_mul_i32 s60, s60, 21504
    s_and_b32 s61, s61, 7
    s_lshr_b32 s68, s69, 6
    s_lshl_b32 s68, s68, 3
    s_add_u32 s61, s61, s68
    s_mul_i32 s61, s61, 704
    s_add_u32 s60, s60, s61
    s_add_u32 s60, s60, 13510656
    buffer_load_dwordx4 v[132:135], v141, s[32:35], s60 offen sc1
    s_add_u32 s69, s69, 1
    s_and_b32 s61, s69, 63
    s_add_u32 s61, s61, 3
    s_lshr_b32 s60, s61, 3
    s_mul_i32 s60, s60, 21504
    s_and_b32 s61, s61, 7
    s_lshr_b32 s68, s69, 6
    s_lshl_b32 s68, s68, 3
    s_add_u32 s61, s61, s68
    s_mul_i32 s61, s61, 704
    s_add_u32 s60, s60, s61
    s_add_u32 s60, s60, 13510656
    buffer_load_dwordx4 v[136:139], v141, s[32:35], s60 offen sc1
    s_waitcnt vmcnt(0)
    v_mfma_f32_32x32x16_bf16 v[84:99], v[24:27], v[16:19], v[116:131]
    v_mfma_f32_32x32x8_bf16 v[84:99], v[22:23], v[20:21], v[84:99]
    s_nop 11
    v_exp_f32 v84, v84
    v_exp_f32 v85, v85
    v_exp_f32 v86, v86
    v_exp_f32 v87, v87
    v_exp_f32 v88, v88
    v_exp_f32 v89, v89
    v_exp_f32 v90, v90
    v_exp_f32 v91, v91
    v_exp_f32 v92, v92
    v_exp_f32 v93, v93
    v_exp_f32 v94, v94
    v_exp_f32 v95, v95
    v_exp_f32 v96, v96
    v_exp_f32 v97, v97
    v_exp_f32 v98, v98
    v_exp_f32 v99, v99
    s_nop 0
    v_cvt_pk_bf16_f32 v36, v84, v85
    v_cvt_pk_bf16_f32 v37, v86, v87
    v_cvt_pk_bf16_f32 v38, v88, v89
    v_cvt_pk_bf16_f32 v39, v90, v91
    v_cvt_pk_bf16_f32 v40, v92, v93
    v_cvt_pk_bf16_f32 v41, v94, v95
    v_cvt_pk_bf16_f32 v42, v96, v97
    v_cvt_pk_bf16_f32 v43, v98, v99
    s_nop 1
    v_mfma_f32_32x32x16_bf16 v[68:83], v[132:135], v[36:39], v[68:83]
    v_mfma_f32_32x32x16_bf16 v[68:83], v[136:139], v[40:43], v[68:83]
    s_add_u32 s44, s44, 1
    s_cmp_lt_u32 s44, 64
    s_cbranch_scc1 Lsafe_81
    s_nop 11
    v_mov_b32 v9, v76
    v_mov_b32 v10, v76
    s_nop 1
    v_permlane32_swap_b32 v9, v10
    s_nop 1
    s_branch Lfin_66
Lend:
    s_endpgm
.section .rodata,"a"
.p2align 6
.amdhsa_kernel concat_heads__grouped_kv_mqa__spectral_gfnet__prompt_kernel
  .amdhsa_next_free_vgpr 168
  .amdhsa_next_free_sgpr 96
  .amdhsa_accum_offset 168
  .amdhsa_group_segment_fixed_size 0
  .amdhsa_kernarg_size 88
  .amdhsa_user_sgpr_count 2
  .amdhsa_user_sgpr_kernarg_segment_ptr 1
  .amdhsa_system_sgpr_workgroup_id_x 1
.end_amdhsa_kernel
```
